```python
import torch

def _softmax(x, axis=-1):
    return torch.softmax(x, dim=axis)
def _gelu(x):
    return torch.nn.functional.gelu(x, approximate="tanh")
def _silu(x):
    return torch.nn.functional.silu(x)
def _sigmoid(x):
    return torch.sigmoid(x)
def _layernorm(x, axis=-1, eps=1e-5):
    m = x.mean(dim=axis, keepdim=True)
    v = x.var(dim=axis, keepdim=True, unbiased=False)
    return (x - m) / torch.sqrt(v + eps)
def _scatter_add(tgt, idx, src, axis=0):
    return tgt.clone().index_add_(axis, idx, src)
def _segment_sum(src, seg, n):
    out = torch.zeros((n,) + src.shape[1:], dtype=src.dtype)
    return out.index_add_(0, seg, src)
def _pad(x, pw):
    flat = tuple(v for pair in reversed(pw) for v in pair)
    return torch.nn.functional.pad(x, flat)

kernel_name = 'gated_mix__softmax_full_mha__softmax_full_mha__prompt'

def setup_inputs():

    _w = (lambda a: (lambda t: t.to(torch.bfloat16) if t.is_floating_point() else t)(torch.as_tensor(a)))
    def _A_setup():
        B, S, D = 1, 2048, 576
        return {
            "x": _w((lambda *s: torch.randn(*s, dtype=torch.bfloat16) * 0.05)(B, S, D)),
            "wqkv": _w((lambda *s: torch.randn(*s, dtype=torch.bfloat16) * 0.8)(D, 3 * D)),
            "wo": _w((lambda *s: torch.randn(*s, dtype=torch.bfloat16) * 0.05)(D, D)),
        }
    _A_in = _A_setup()

    def _B_setup():
        B, S, D = 1, 2048, 576
        return {
            "x": _w((lambda *s: torch.randn(*s, dtype=torch.bfloat16) * 0.05)(B, S, D)),
            "wqkv": _w((lambda *s: torch.randn(*s, dtype=torch.bfloat16) * 0.8)(D, 3 * D)),
            "wo": _w((lambda *s: torch.randn(*s, dtype=torch.bfloat16) * 0.05)(D, D)),
        }
    _B_in = _B_setup()

    return {
        "A_x": _A_in["x"],
        "A_wqkv": _A_in["wqkv"],
        "A_wo": _A_in["wo"],
        "B_x": _B_in["x"],
        "B_wqkv": _B_in["wqkv"],
        "B_wo": _B_in["wo"],
        "gate_w": _w((lambda *s: torch.randn(*s, dtype=torch.bfloat16) * 0.05)(576) * 16.0),
    }

def reference(A_x, A_wqkv, A_wo, B_x, B_wqkv, B_wo, gate_w):
    def _A_ref(x, wqkv, wo):
        B, S, D = x.shape
        H = 32; Dh = D // H
        qkv = (lambda x, *d: x.permute(*d))((x @ wqkv).reshape(B, S, 3, H, Dh), 2, 0, 3, 1, 4)
        q, k, v = qkv[0], qkv[1], qkv[2]
        scale = Dh ** -0.5
        scores = torch.einsum("bhqd,bhkd->bhqk", q, k) * scale
        p = _softmax(scores, axis=-1)
        o = torch.einsum("bhqk,bhkd->bhqd", p, v)
        return (lambda x, *d: x.permute(*d))(o, 0, 2, 1, 3).reshape(B, S, D) @ wo

    def _B_ref(x, wqkv, wo):
        B, S, D = x.shape
        H = 32; Dh = D // H
        qkv = (lambda x, *d: x.permute(*d))((x @ wqkv).reshape(B, S, 3, H, Dh), 2, 0, 3, 1, 4)
        q, k, v = qkv[0], qkv[1], qkv[2]
        scale = Dh ** -0.5
        scores = torch.einsum("bhqd,bhkd->bhqk", q, k) * scale
        p = _softmax(scores, axis=-1)
        o = torch.einsum("bhqk,bhkd->bhqd", p, v)
        return (lambda x, *d: x.permute(*d))(o, 0, 2, 1, 3).reshape(B, S, D) @ wo

    x = A_x
    g = _sigmoid((x * gate_w).sum(-1, keepdims=True))
    a = _A_ref(x, A_wqkv, A_wo)
    b = _B_ref(x, B_wqkv, B_wo)
    return g * a + (1 - g) * b
```

```asm
; @launch grid=(256,1,1) block=(576,1,1) lds=163840
.amdgcn_target "amdgcn-amd-amdhsa--gfx950"
.text
.globl gated_mix__softmax_full_mha__softmax_full_mha__prompt_kernel
.p2align 8
.type gated_mix__softmax_full_mha__softmax_full_mha__prompt_kernel,@function
gated_mix__softmax_full_mha__softmax_full_mha__prompt_kernel:
    s_cmp_ge_u32 s2, 256
    s_cbranch_scc1 L_exit
    s_load_dwordx16 s[44:59], s[0:1], 0
    s_load_dwordx4 s[60:63], s[0:1], 64
    v_readfirstlane_b32 s24, v0
    v_and_b32 v1, 63, v0
    s_and_b32 s29, s2, 7
    s_lshl_b32 s29, s29, 2
    s_bfe_u32 s30, s2, 0x10006
    s_lshl_b32 s30, s30, 1
    s_or_b32 s26, s29, s30
    s_lshr_b32 s29, s2, 7
    s_bfe_u32 s30, s2, 0x10001
    s_xor_b32 s29, s29, s30
    s_xor_b32 s29, s29, 1
    s_or_b32 s26, s26, s29
    s_bfe_u32 s25, s2, 0x30003
    s_lshr_b32 s27, s26, 4
    s_and_b32 s28, s26, 15
    s_lshr_b32 s24, s24, 6
    v_lshrrev_b32 v2, 4, v1
    v_and_b32 v3, 15, v1
    s_mov_b32 s4, 0xa3928170
    s_mov_b32 s5, 0xfe6d5c4b
    s_lshl_b32 s29, s28, 2
    s_lshr_b64 s[4:5], s[4:5], s29
    s_mul_i32 s36, s28, 72
    s_and_b32 s28, s4, 15
    s_mov_b32 s41, s25
    s_cmp_lt_u32 s24, 8
    s_cbranch_scc1 L_compute
    s_setprio 3
    v_lshlrev_b32 v4, 1, v2
    v_or_b32 v4, 0, v4
    v_xor_b32 v4, v4, v3
    v_min_u32 v4, 14, v4
    v_mul_u32_u24 v5, 52, v4
    v_lshrrev_b32 v5, 8, v5
    v_lshlrev_b32 v4, 4, v4
    v_mul_u32_u24 v6, 1072, v5
    v_add_u32 v4, v4, v6
    v_and_b32 v5, 2, v5
    v_lshlrev_b32 v5, 2, v5
    v_sub_u32 v4, v4, v5
    v_mul_u32_u24 v5, 3456, v2
    v_add_u32 v8, v4, v5
    v_lshlrev_b32 v4, 1, v2
    v_or_b32 v4, 8, v4
    v_xor_b32 v4, v4, v3
    v_min_u32 v4, 14, v4
    v_mul_u32_u24 v5, 52, v4
    v_lshrrev_b32 v5, 8, v5
    v_lshlrev_b32 v4, 4, v4
    v_mul_u32_u24 v6, 1072, v5
    v_add_u32 v4, v4, v6
    v_and_b32 v5, 2, v5
    v_lshlrev_b32 v5, 2, v5
    v_sub_u32 v4, v4, v5
    v_mul_u32_u24 v5, 3456, v2
    v_add_u32 v9, v4, v5
    v_lshrrev_b32 v4, 3, v1
    v_mul_u32_u24 v4, 1152, v4
    v_and_b32 v5, 7, v1
    v_xor_b32 v5, v5, v2
    v_lshl_add_u32 v10, v5, 4, v4
    v_xor_b32 v5, 4, v5
    v_lshl_add_u32 v4, v5, 4, v4
    v_add_u32 v11, 9216, v4
    v_lshlrev_b32 v12, 4, v1
    s_mul_i32 s37, s25, 294912
    s_lshl_b32 s29, s41, 7
    s_add_u32 s37, s37, s29
    s_mul_i32 s29, s41, 221184
    s_add_u32 s36, s36, s29
    s_mov_b32 s38, s41
    s_mov_b32 m0, 155648
    s_waitcnt lgkmcnt(0)
    s_cmp_eq_u32 s27, 0
    s_cselect_b32 s46, s46, s52
    s_cselect_b32 s47, s47, s53
    s_mov_b32 s8, s46
    s_and_b32 s9, s47, 0xffff
    s_mov_b32 s10, 1990656
    s_mov_b32 s11, 0x00020000
    s_mov_b32 s4, s44
    s_and_b32 s5, s45, 0xffff
    s_mov_b32 s6, 2359296
    s_mov_b32 s7, 0x00020000
    s_mov_b32 s16, s56
    s_and_b32 s17, s57, 0xffff
    s_mov_b32 s18, 1152
    s_mov_b32 s19, 0x00020000
    buffer_load_dwordx4 v12, s[16:19], 0 offen lds
    s_mov_b64 exec, 0xff
    buffer_load_dwordx4 v12, s[16:19], 0 offen offset:1024 lds
    s_mov_b64 exec, -1
    s_mov_b32 m0, 156800
    s_nop 0
    buffer_load_dwordx4 v12, s[16:19], 0 offen lds
    s_mov_b32 s64, 8192
    s_mov_b32 s33, 90112
    s_mov_b32 s65, 24576
    s_mov_b32 s34, 122880
    s_mov_b32 s66, 40960
    s_mov_b32 s35, 57344
    s_mov_b32 s12, s62
    s_and_b32 s13, s63, 0xffff
    s_mov_b32 s14, 15209472
    s_mov_b32 s15, 0x00020000
    s_mov_b32 s20, s60
    s_and_b32 s21, s61, 0xffff
    s_mov_b32 s22, 256
    s_mov_b32 s23, 0x00020000
    v_mov_b32 v16, 0
    v_lshlrev_b32 v14, 2, v1
    s_mov_b32 s41, 0
    s_cmp_eq_u32 s2, 0
    s_cselect_b32 s32, 2, 15
    s_mov_b32 s30, 221184
    s_mov_b32 s31, 128
    v_add_u32 v19, 12800, v8
    v_add_u32 v20, 25600, v9
    v_add_u32 v21, 38400, v9
    v_add_u32 v22, 16384, v10
    v_add_u32 v23, 15360, v11
    v_subrev_u32 v11, 1024, v11
L_ld_pair:
    s_waitcnt vmcnt(59)
    s_add_u32 m0, s33, 0
    s_add_u32 s29, s37, 0
    buffer_load_dwordx4 v10, s[4:7], s29 offen offset:0 lds
    buffer_load_dwordx4 v11, s[4:7], s29 offen offset:1024 lds
    buffer_load_dwordx4 v22, s[4:7], s29 offen offset:2048 lds
    buffer_load_dwordx4 v23, s[4:7], s29 offen offset:3072 lds
    s_waitcnt vmcnt(59)
    s_add_u32 m0, s64, 0
    s_add_u32 s29, s36, 0
    buffer_load_dwordx4 v8, s[8:11], s29 offen offset:0 lds
    buffer_load_dwordx4 v19, s[8:11], s29 offen offset:1024 lds
    buffer_load_dwordx4 v20, s[8:11], s29 offen offset:2048 lds
    buffer_load_dwordx4 v21, s[8:11], s29 offen offset:3072 lds
    s_waitcnt vmcnt(59)
    s_add_u32 m0, s33, 4096
    s_add_u32 s29, s37, 36864
    buffer_load_dwordx4 v10, s[4:7], s29 offen offset:0 lds
    buffer_load_dwordx4 v11, s[4:7], s29 offen offset:1024 lds
    buffer_load_dwordx4 v22, s[4:7], s29 offen offset:2048 lds
    buffer_load_dwordx4 v23, s[4:7], s29 offen offset:3072 lds
    s_waitcnt vmcnt(59)
    s_add_u32 m0, s33, 8192
    s_add_u32 s29, s37, 73728
    buffer_load_dwordx4 v10, s[4:7], s29 offen offset:0 lds
    buffer_load_dwordx4 v11, s[4:7], s29 offen offset:1024 lds
    buffer_load_dwordx4 v22, s[4:7], s29 offen offset:2048 lds
    buffer_load_dwordx4 v23, s[4:7], s29 offen offset:3072 lds
    s_waitcnt vmcnt(59)
    s_add_u32 m0, s64, 4096
    s_add_u32 s29, s36, 55296
    buffer_load_dwordx4 v8, s[8:11], s29 offen offset:0 lds
    buffer_load_dwordx4 v19, s[8:11], s29 offen offset:1024 lds
    buffer_load_dwordx4 v20, s[8:11], s29 offen offset:2048 lds
    buffer_load_dwordx4 v21, s[8:11], s29 offen offset:3072 lds
    s_waitcnt vmcnt(59)
    s_add_u32 m0, s33, 12288
    s_add_u32 s29, s37, 110592
    buffer_load_dwordx4 v10, s[4:7], s29 offen offset:0 lds
    buffer_load_dwordx4 v11, s[4:7], s29 offen offset:1024 lds
    buffer_load_dwordx4 v22, s[4:7], s29 offen offset:2048 lds
    buffer_load_dwordx4 v23, s[4:7], s29 offen offset:3072 lds
    s_cmp_eq_u32 s41, 0
    s_cbranch_scc1 L_ld_first
    s_waitcnt vmcnt(24)
    s_barrier
    s_cmp_eq_u32 s41, s32
    s_cbranch_scc1 L_ld_ready
L_ld_second:
    s_waitcnt vmcnt(59)
    s_add_u32 m0, s33, 16384
    s_add_u32 s29, s37, 147456
    buffer_load_dwordx4 v10, s[4:7], s29 offen offset:0 lds
    buffer_load_dwordx4 v11, s[4:7], s29 offen offset:1024 lds
    buffer_load_dwordx4 v22, s[4:7], s29 offen offset:2048 lds
    buffer_load_dwordx4 v23, s[4:7], s29 offen offset:3072 lds
    s_waitcnt vmcnt(59)
    s_add_u32 m0, s64, 8192
    s_add_u32 s29, s36, 110592
    buffer_load_dwordx4 v8, s[8:11], s29 offen offset:0 lds
    buffer_load_dwordx4 v19, s[8:11], s29 offen offset:1024 lds
    buffer_load_dwordx4 v20, s[8:11], s29 offen offset:2048 lds
    buffer_load_dwordx4 v21, s[8:11], s29 offen offset:3072 lds
    s_waitcnt vmcnt(59)
    s_add_u32 m0, s33, 20480
    s_add_u32 s29, s37, 184320
    buffer_load_dwordx4 v10, s[4:7], s29 offen offset:0 lds
    buffer_load_dwordx4 v11, s[4:7], s29 offen offset:1024 lds
    buffer_load_dwordx4 v22, s[4:7], s29 offen offset:2048 lds
    buffer_load_dwordx4 v23, s[4:7], s29 offen offset:3072 lds
    s_waitcnt vmcnt(59)
    s_add_u32 m0, s33, 24576
    s_add_u32 s29, s37, 221184
    buffer_load_dwordx4 v10, s[4:7], s29 offen offset:0 lds
    buffer_load_dwordx4 v11, s[4:7], s29 offen offset:1024 lds
    buffer_load_dwordx4 v22, s[4:7], s29 offen offset:2048 lds
    buffer_load_dwordx4 v23, s[4:7], s29 offen offset:3072 lds
    s_waitcnt vmcnt(59)
    s_add_u32 m0, s64, 12288
    s_add_u32 s29, s36, 165888
    buffer_load_dwordx4 v8, s[8:11], s29 offen offset:0 lds
    buffer_load_dwordx4 v19, s[8:11], s29 offen offset:1024 lds
    buffer_load_dwordx4 v20, s[8:11], s29 offen offset:2048 lds
    buffer_load_dwordx4 v21, s[8:11], s29 offen offset:3072 lds
    s_waitcnt vmcnt(59)
    s_add_u32 m0, s33, 28672
    s_add_u32 s29, s37, 258048
    buffer_load_dwordx4 v10, s[4:7], s29 offen offset:0 lds
    buffer_load_dwordx4 v11, s[4:7], s29 offen offset:1024 lds
    buffer_load_dwordx4 v22, s[4:7], s29 offen offset:2048 lds
    buffer_load_dwordx4 v23, s[4:7], s29 offen offset:3072 lds
    s_mov_b32 s29, s64
    s_mov_b32 s64, s65
    s_mov_b32 s65, s66
    s_mov_b32 s66, s29
    s_mov_b32 s29, s33
    s_mov_b32 s33, s34
    s_mov_b32 s34, s35
    s_mov_b32 s35, s29
    s_add_u32 s38, s38, 1
    s_cmp_eq_u32 s38, 9
    s_cselect_b32 s29, 4293197824, s30
    s_add_u32 s36, s36, s29
    s_cmp_eq_u32 s38, 9
    s_cselect_b32 s29, 4294966272, s31
    s_add_u32 s37, s37, s29
    s_add_u32 s41, s41, 1
    s_cmp_lt_u32 s41, 8
    s_cbranch_scc1 L_ld_pair
    s_waitcnt vmcnt(59)
    s_add_u32 m0, s33, 0
    s_add_u32 s29, s37, 0
    buffer_load_dwordx4 v10, s[4:7], s29 offen offset:0 lds
    buffer_load_dwordx4 v11, s[4:7], s29 offen offset:1024 lds
    buffer_load_dwordx4 v22, s[4:7], s29 offen offset:2048 lds
    buffer_load_dwordx4 v23, s[4:7], s29 offen offset:3072 lds
    s_waitcnt vmcnt(59)
    s_add_u32 m0, s64, 0
    s_add_u32 s29, s36, 0
    buffer_load_dwordx4 v8, s[8:11], s29 offen offset:0 lds
    buffer_load_dwordx4 v19, s[8:11], s29 offen offset:1024 lds
    buffer_load_dwordx4 v20, s[8:11], s29 offen offset:2048 lds
    buffer_load_dwordx4 v21, s[8:11], s29 offen offset:3072 lds
    s_waitcnt vmcnt(59)
    s_add_u32 m0, s33, 4096
    s_add_u32 s29, s37, 36864
    buffer_load_dwordx4 v10, s[4:7], s29 offen offset:0 lds
    buffer_load_dwordx4 v11, s[4:7], s29 offen offset:1024 lds
    buffer_load_dwordx4 v22, s[4:7], s29 offen offset:2048 lds
    buffer_load_dwordx4 v23, s[4:7], s29 offen offset:3072 lds
    s_waitcnt vmcnt(59)
    s_add_u32 m0, s33, 8192
    s_add_u32 s29, s37, 73728
    buffer_load_dwordx4 v10, s[4:7], s29 offen offset:0 lds
    buffer_load_dwordx4 v11, s[4:7], s29 offen offset:1024 lds
    buffer_load_dwordx4 v22, s[4:7], s29 offen offset:2048 lds
    buffer_load_dwordx4 v23, s[4:7], s29 offen offset:3072 lds
    s_waitcnt vmcnt(59)
    s_add_u32 m0, s64, 4096
    s_add_u32 s29, s36, 55296
    buffer_load_dwordx4 v8, s[8:11], s29 offen offset:0 lds
    buffer_load_dwordx4 v19, s[8:11], s29 offen offset:1024 lds
    buffer_load_dwordx4 v20, s[8:11], s29 offen offset:2048 lds
    buffer_load_dwordx4 v21, s[8:11], s29 offen offset:3072 lds
    s_waitcnt vmcnt(59)
    s_add_u32 m0, s33, 12288
    s_add_u32 s29, s37, 110592
    buffer_load_dwordx4 v10, s[4:7], s29 offen offset:0 lds
    buffer_load_dwordx4 v11, s[4:7], s29 offen offset:1024 lds
    buffer_load_dwordx4 v22, s[4:7], s29 offen offset:2048 lds
    buffer_load_dwordx4 v23, s[4:7], s29 offen offset:3072 lds
    s_waitcnt vmcnt(24)
    s_barrier
    s_waitcnt vmcnt(59)
    s_add_u32 m0, s33, 16384
    s_add_u32 s29, s37, 147456
    buffer_load_dwordx4 v10, s[4:7], s29 offen offset:0 lds
    buffer_load_dwordx4 v11, s[4:7], s29 offen offset:1024 lds
    buffer_load_dwordx4 v22, s[4:7], s29 offen offset:2048 lds
    buffer_load_dwordx4 v23, s[4:7], s29 offen offset:3072 lds
    s_waitcnt vmcnt(59)
    s_add_u32 m0, s33, 20480
    s_add_u32 s29, s37, 184320
    buffer_load_dwordx4 v10, s[4:7], s29 offen offset:0 lds
    buffer_load_dwordx4 v11, s[4:7], s29 offen offset:1024 lds
    buffer_load_dwordx4 v22, s[4:7], s29 offen offset:2048 lds
    buffer_load_dwordx4 v23, s[4:7], s29 offen offset:3072 lds
    s_waitcnt vmcnt(59)
    s_add_u32 m0, s33, 24576
    s_add_u32 s29, s37, 221184
    buffer_load_dwordx4 v10, s[4:7], s29 offen offset:0 lds
    buffer_load_dwordx4 v11, s[4:7], s29 offen offset:1024 lds
    buffer_load_dwordx4 v22, s[4:7], s29 offen offset:2048 lds
    buffer_load_dwordx4 v23, s[4:7], s29 offen offset:3072 lds
    s_waitcnt vmcnt(59)
    s_add_u32 m0, s33, 28672
    s_add_u32 s29, s37, 258048
    buffer_load_dwordx4 v10, s[4:7], s29 offen offset:0 lds
    buffer_load_dwordx4 v11, s[4:7], s29 offen offset:1024 lds
    buffer_load_dwordx4 v22, s[4:7], s29 offen offset:2048 lds
    buffer_load_dwordx4 v23, s[4:7], s29 offen offset:3072 lds
    s_waitcnt vmcnt(59)
    s_add_u32 m0, s64, 8192
    s_add_u32 s29, s36, 110592
    buffer_load_dwordx4 v8, s[8:11], s29 offen offset:0 lds
    buffer_load_dwordx4 v19, s[8:11], s29 offen offset:1024 lds
    buffer_load_dwordx4 v20, s[8:11], s29 offen offset:2048 lds
    buffer_load_dwordx4 v21, s[8:11], s29 offen offset:3072 lds
    s_waitcnt vmcnt(59)
    s_add_u32 m0, s64, 12288
    s_add_u32 s29, s36, 165888
    buffer_load_dwordx4 v8, s[8:11], s29 offen offset:0 lds
    buffer_load_dwordx4 v19, s[8:11], s29 offen offset:1024 lds
    buffer_load_dwordx4 v20, s[8:11], s29 offen offset:2048 lds
    buffer_load_dwordx4 v21, s[8:11], s29 offen offset:3072 lds
    s_waitcnt vmcnt(8)
    s_barrier
    s_waitcnt vmcnt(0)
    s_barrier
    s_mov_b64 exec, 1
    buffer_load_dword v15, v16, s[20:23], 0 offen sc1
    s_lshl_b32 s39, s26, 3
    s_add_u32 s36, s39, s25
    s_mul_i32 s36, s36, 40960
    s_mul_i32 s39, s39, 40960
    s_lshl_b32 s34, s26, 7
    s_add_u32 s34, s34, 15204352
    s_lshl_b32 s33, s25, 2
    s_add_u32 s33, s33, s34
    s_mov_b32 s41, 262144
L_spin_rdy:
    s_waitcnt vmcnt(0)
    v_cmp_eq_u32 vcc, 0, v15
    s_cbranch_vccz L_got_rdy
    s_sleep 1
    buffer_load_dword v15, v16, s[20:23], 0 offen sc1
    s_sub_u32 s41, s41, 1
    s_cmp_lg_u32 s41, 0
    s_cbranch_scc1 L_spin_rdy
    s_waitcnt vmcnt(0)
L_got_rdy:
    s_mov_b64 exec, -1
    v_mul_u32_u24 v2, 57, v1
    v_lshrrev_b32 v2, 9, v2
    v_mul_u32_u24 v2, 1008, v2
    v_lshl_add_u32 v2, v1, 4, v2
    s_lshr_b32 s67, s2, 5
    s_mul_i32 s67, s67, 144
    v_add_u32 v13, s67, v2
    v_add_u32 v17, 6048, v13
    v_add_u32 v18, 12096, v13
    s_barrier
    s_cmp_ge_u32 s25, 3
    s_cbranch_scc1 L_first_chunk
L_publish:
    ds_read_b128 v[24:27], v12 offset:0
    ds_read_b128 v[28:31], v12 offset:1024
    ds_read_b128 v[32:35], v12 offset:2048
    ds_read_b128 v[36:39], v12 offset:3072
    ds_read_b128 v[40:43], v12 offset:4096
    ds_read_b128 v[44:47], v12 offset:5120
    ds_read_b128 v[48:51], v12 offset:6144
    ds_read_b128 v[52:55], v12 offset:7168
    ds_read_b128 v[56:59], v12 offset:8192
    ds_read_b128 v[60:63], v12 offset:9216
    ds_read_b128 v[64:67], v12 offset:10240
    ds_read_b128 v[68:71], v12 offset:11264
    ds_read_b128 v[72:75], v12 offset:12288
    s_waitcnt lgkmcnt(12)
    buffer_store_dwordx4 v[24:27], v12, s[12:15], s36 offen offset:0 sc1
    ds_read_b128 v[76:79], v12 offset:13312
    s_waitcnt lgkmcnt(12)
    buffer_store_dwordx4 v[28:31], v12, s[12:15], s36 offen offset:1024 sc1
    ds_read_b128 v[80:83], v12 offset:14336
    s_waitcnt lgkmcnt(12)
    buffer_store_dwordx4 v[32:35], v12, s[12:15], s36 offen offset:2048 sc1
    ds_read_b128 v[84:87], v12 offset:15360
    s_waitcnt lgkmcnt(12)
    buffer_store_dwordx4 v[36:39], v12, s[12:15], s36 offen offset:3072 sc1
    s_add_u32 s36, s36, 4096
    ds_read_b128 v[88:91], v12 offset:16384
    s_waitcnt lgkmcnt(12)
    buffer_store_dwordx4 v[40:43], v12, s[12:15], s36 offen offset:0 sc1
    ds_read_b128 v[92:95], v12 offset:17408
    s_waitcnt lgkmcnt(12)
    buffer_store_dwordx4 v[44:47], v12, s[12:15], s36 offen offset:1024 sc1
    ds_read_b128 v[96:99], v12 offset:18432
    s_waitcnt lgkmcnt(12)
    buffer_store_dwordx4 v[48:51], v12, s[12:15], s36 offen offset:2048 sc1
    ds_read_b128 v[100:103], v12 offset:19456
    s_waitcnt lgkmcnt(12)
    buffer_store_dwordx4 v[52:55], v12, s[12:15], s36 offen offset:3072 sc1
    s_add_u32 s36, s36, 4096
    ds_read_b128 v[104:107], v12 offset:20480
    s_waitcnt lgkmcnt(12)
    buffer_store_dwordx4 v[56:59], v12, s[12:15], s36 offen offset:0 sc1
    ds_read_b128 v[108:111], v12 offset:21504
    s_waitcnt lgkmcnt(12)
    buffer_store_dwordx4 v[60:63], v12, s[12:15], s36 offen offset:1024 sc1
    ds_read_b128 v[112:115], v12 offset:22528
    s_waitcnt lgkmcnt(12)
    buffer_store_dwordx4 v[64:67], v12, s[12:15], s36 offen offset:2048 sc1
    ds_read_b128 v[116:119], v12 offset:23552
    s_waitcnt lgkmcnt(12)
    buffer_store_dwordx4 v[68:71], v12, s[12:15], s36 offen offset:3072 sc1
    s_add_u32 s36, s36, 4096
    ds_read_b128 v[24:27], v12 offset:24576
    s_waitcnt lgkmcnt(12)
    buffer_store_dwordx4 v[72:75], v12, s[12:15], s36 offen offset:0 sc1
    ds_read_b128 v[28:31], v12 offset:25600
    s_waitcnt lgkmcnt(12)
    buffer_store_dwordx4 v[76:79], v12, s[12:15], s36 offen offset:1024 sc1
    ds_read_b128 v[32:35], v12 offset:26624
    s_waitcnt lgkmcnt(12)
    buffer_store_dwordx4 v[80:83], v12, s[12:15], s36 offen offset:2048 sc1
    ds_read_b128 v[36:39], v12 offset:27648
    s_waitcnt lgkmcnt(12)
    buffer_store_dwordx4 v[84:87], v12, s[12:15], s36 offen offset:3072 sc1
    s_add_u32 s36, s36, 4096
    ds_read_b128 v[40:43], v12 offset:28672
    s_waitcnt lgkmcnt(12)
    buffer_store_dwordx4 v[88:91], v12, s[12:15], s36 offen offset:0 sc1
    ds_read_b128 v[44:47], v12 offset:29696
    s_waitcnt lgkmcnt(12)
    buffer_store_dwordx4 v[92:95], v12, s[12:15], s36 offen offset:1024 sc1
    ds_read_b128 v[48:51], v12 offset:30720
    s_waitcnt lgkmcnt(12)
    buffer_store_dwordx4 v[96:99], v12, s[12:15], s36 offen offset:2048 sc1
    ds_read_b128 v[52:55], v12 offset:31744
    s_waitcnt lgkmcnt(12)
    buffer_store_dwordx4 v[100:103], v12, s[12:15], s36 offen offset:3072 sc1
    s_add_u32 s36, s36, 4096
    ds_read_b128 v[56:59], v12 offset:32768
    s_waitcnt lgkmcnt(12)
    buffer_store_dwordx4 v[104:107], v12, s[12:15], s36 offen offset:0 sc1
    ds_read_b128 v[60:63], v12 offset:33792
    s_waitcnt lgkmcnt(12)
    buffer_store_dwordx4 v[108:111], v12, s[12:15], s36 offen offset:1024 sc1
    ds_read_b128 v[64:67], v12 offset:34816
    s_waitcnt lgkmcnt(12)
    buffer_store_dwordx4 v[112:115], v12, s[12:15], s36 offen offset:2048 sc1
    ds_read_b128 v[68:71], v12 offset:35840
    s_waitcnt lgkmcnt(12)
    buffer_store_dwordx4 v[116:119], v12, s[12:15], s36 offen offset:3072 sc1
    s_add_u32 s36, s36, 4096
    ds_read_b128 v[72:75], v12 offset:36864
    s_waitcnt lgkmcnt(12)
    buffer_store_dwordx4 v[24:27], v12, s[12:15], s36 offen offset:0 sc1
    ds_read_b128 v[76:79], v12 offset:37888
    s_waitcnt lgkmcnt(12)
    buffer_store_dwordx4 v[28:31], v12, s[12:15], s36 offen offset:1024 sc1
    ds_read_b128 v[80:83], v12 offset:38912
    s_waitcnt lgkmcnt(12)
    buffer_store_dwordx4 v[32:35], v12, s[12:15], s36 offen offset:2048 sc1
    ds_read_b128 v[84:87], v12 offset:39936
    s_waitcnt lgkmcnt(12)
    buffer_store_dwordx4 v[36:39], v12, s[12:15], s36 offen offset:3072 sc1
    s_add_u32 s36, s36, 4096
    s_waitcnt lgkmcnt(11)
    buffer_store_dwordx4 v[40:43], v12, s[12:15], s36 offen offset:0 sc1
    s_waitcnt lgkmcnt(10)
    buffer_store_dwordx4 v[44:47], v12, s[12:15], s36 offen offset:1024 sc1
    s_waitcnt lgkmcnt(9)
    buffer_store_dwordx4 v[48:51], v12, s[12:15], s36 offen offset:2048 sc1
    s_waitcnt lgkmcnt(8)
    buffer_store_dwordx4 v[52:55], v12, s[12:15], s36 offen offset:3072 sc1
    s_add_u32 s36, s36, 4096
    s_waitcnt lgkmcnt(7)
    buffer_store_dwordx4 v[56:59], v12, s[12:15], s36 offen offset:0 sc1
    s_waitcnt lgkmcnt(6)
    buffer_store_dwordx4 v[60:63], v12, s[12:15], s36 offen offset:1024 sc1
    s_waitcnt lgkmcnt(5)
    buffer_store_dwordx4 v[64:67], v12, s[12:15], s36 offen offset:2048 sc1
    s_waitcnt lgkmcnt(4)
    buffer_store_dwordx4 v[68:71], v12, s[12:15], s36 offen offset:3072 sc1
    s_add_u32 s36, s36, 4096
    s_waitcnt lgkmcnt(3)
    buffer_store_dwordx4 v[72:75], v12, s[12:15], s36 offen offset:0 sc1
    s_waitcnt lgkmcnt(2)
    buffer_store_dwordx4 v[76:79], v12, s[12:15], s36 offen offset:1024 sc1
    s_waitcnt lgkmcnt(1)
    buffer_store_dwordx4 v[80:83], v12, s[12:15], s36 offen offset:2048 sc1
    s_waitcnt lgkmcnt(0)
    buffer_store_dwordx4 v[84:87], v12, s[12:15], s36 offen offset:3072 sc1
    s_add_u32 s36, s36, 4096
    s_waitcnt vmcnt(0)
    v_mov_b32 v15, 1
    s_mov_b64 exec, 1
    buffer_store_dword v15, v16, s[12:15], s33 offen sc1
    s_mov_b64 exec, -1
    s_cmp_ge_u32 s25, 3
    s_cbranch_scc1 L_published
L_first_chunk:
    s_cmp_gt_u32 s25, 0
    s_cselect_b64 exec, 1, 2
    buffer_load_dword v15, v14, s[12:15], s34 offen sc1
    s_mov_b32 s41, 262144
L_spin_kv1:
    s_waitcnt vmcnt(0)
    v_cmp_eq_u32 vcc, 0, v15
    s_cbranch_vccz L_got_kv1
    s_sleep 1
    buffer_load_dword v15, v14, s[12:15], s34 offen sc1
    s_sub_u32 s41, s41, 1
    s_cmp_lg_u32 s41, 0
    s_cbranch_scc1 L_spin_kv1
    s_waitcnt vmcnt(0)
L_got_kv1:
    s_mov_b64 exec, -1
    s_cmp_gt_u32 s25, 0
    s_cselect_b32 s29, 0, 1
    s_mul_i32 s29, s29, 40960
    s_add_u32 s40, s29, s39
    s_mov_b32 s38, 40960
    s_waitcnt vmcnt(55)
    s_add_u32 m0, s38, 0
    s_add_u32 s29, s40, 0
    buffer_load_dwordx4 v12, s[12:15], s29 offen offset:0 sc1 lds
    buffer_load_dwordx4 v12, s[12:15], s29 offen offset:1024 sc1 lds
    buffer_load_dwordx4 v12, s[12:15], s29 offen offset:2048 sc1 lds
    buffer_load_dwordx4 v12, s[12:15], s29 offen offset:3072 sc1 lds
    s_add_u32 m0, s38, 4096
    s_add_u32 s29, s40, 4096
    buffer_load_dwordx4 v12, s[12:15], s29 offen offset:0 sc1 lds
    buffer_load_dwordx4 v12, s[12:15], s29 offen offset:1024 sc1 lds
    buffer_load_dwordx4 v12, s[12:15], s29 offen offset:2048 sc1 lds
    buffer_load_dwordx4 v12, s[12:15], s29 offen offset:3072 sc1 lds
    s_waitcnt vmcnt(55)
    s_add_u32 m0, s38, 8192
    s_add_u32 s29, s40, 8192
    buffer_load_dwordx4 v12, s[12:15], s29 offen offset:0 sc1 lds
    buffer_load_dwordx4 v12, s[12:15], s29 offen offset:1024 sc1 lds
    buffer_load_dwordx4 v12, s[12:15], s29 offen offset:2048 sc1 lds
    buffer_load_dwordx4 v12, s[12:15], s29 offen offset:3072 sc1 lds
    s_add_u32 m0, s38, 12288
    s_add_u32 s29, s40, 12288
    buffer_load_dwordx4 v12, s[12:15], s29 offen offset:0 sc1 lds
    buffer_load_dwordx4 v12, s[12:15], s29 offen offset:1024 sc1 lds
    buffer_load_dwordx4 v12, s[12:15], s29 offen offset:2048 sc1 lds
    buffer_load_dwordx4 v12, s[12:15], s29 offen offset:3072 sc1 lds
    s_waitcnt vmcnt(55)
    s_add_u32 m0, s38, 16384
    s_add_u32 s29, s40, 16384
    buffer_load_dwordx4 v12, s[12:15], s29 offen offset:0 sc1 lds
    buffer_load_dwordx4 v12, s[12:15], s29 offen offset:1024 sc1 lds
    buffer_load_dwordx4 v12, s[12:15], s29 offen offset:2048 sc1 lds
    buffer_load_dwordx4 v12, s[12:15], s29 offen offset:3072 sc1 lds
    s_add_u32 m0, s38, 20480
    s_add_u32 s29, s40, 20480
    buffer_load_dwordx4 v12, s[12:15], s29 offen offset:0 sc1 lds
    buffer_load_dwordx4 v12, s[12:15], s29 offen offset:1024 sc1 lds
    buffer_load_dwordx4 v12, s[12:15], s29 offen offset:2048 sc1 lds
    buffer_load_dwordx4 v12, s[12:15], s29 offen offset:3072 sc1 lds
    s_waitcnt vmcnt(55)
    s_add_u32 m0, s38, 24576
    s_add_u32 s29, s40, 24576
    buffer_load_dwordx4 v12, s[12:15], s29 offen offset:0 sc1 lds
    buffer_load_dwordx4 v12, s[12:15], s29 offen offset:1024 sc1 lds
    buffer_load_dwordx4 v12, s[12:15], s29 offen offset:2048 sc1 lds
    buffer_load_dwordx4 v12, s[12:15], s29 offen offset:3072 sc1 lds
    s_add_u32 m0, s38, 28672
    s_add_u32 s29, s40, 28672
    buffer_load_dwordx4 v12, s[12:15], s29 offen offset:0 sc1 lds
    buffer_load_dwordx4 v12, s[12:15], s29 offen offset:1024 sc1 lds
    buffer_load_dwordx4 v12, s[12:15], s29 offen offset:2048 sc1 lds
    buffer_load_dwordx4 v12, s[12:15], s29 offen offset:3072 sc1 lds
    s_waitcnt vmcnt(55)
    s_add_u32 m0, s38, 32768
    s_add_u32 s29, s40, 32768
    buffer_load_dwordx4 v12, s[12:15], s29 offen offset:0 sc1 lds
    buffer_load_dwordx4 v12, s[12:15], s29 offen offset:1024 sc1 lds
    buffer_load_dwordx4 v12, s[12:15], s29 offen offset:2048 sc1 lds
    buffer_load_dwordx4 v12, s[12:15], s29 offen offset:3072 sc1 lds
    s_add_u32 m0, s38, 36864
    s_add_u32 s29, s40, 36864
    buffer_load_dwordx4 v12, s[12:15], s29 offen offset:0 sc1 lds
    buffer_load_dwordx4 v12, s[12:15], s29 offen offset:1024 sc1 lds
    buffer_load_dwordx4 v12, s[12:15], s29 offen offset:2048 sc1 lds
    buffer_load_dwordx4 v12, s[12:15], s29 offen offset:3072 sc1 lds
    s_waitcnt vmcnt(0)
    s_barrier
    s_cmp_gt_u32 s25, 1
    s_cselect_b64 exec, 2, 4
    buffer_load_dword v15, v14, s[12:15], s34 offen sc1
    s_mov_b32 s41, 262144
L_spin_kv2:
    s_waitcnt vmcnt(0)
    v_cmp_eq_u32 vcc, 0, v15
    s_cbranch_vccz L_got_kv2
    s_sleep 1
    buffer_load_dword v15, v14, s[12:15], s34 offen sc1
    s_sub_u32 s41, s41, 1
    s_cmp_lg_u32 s41, 0
    s_cbranch_scc1 L_spin_kv2
    s_waitcnt vmcnt(0)
L_got_kv2:
    s_mov_b64 exec, -1
    s_cmp_gt_u32 s25, 1
    s_cselect_b32 s29, 1, 2
    s_mul_i32 s29, s29, 40960
    s_add_u32 s40, s29, s39
    s_mov_b32 s38, 81920
    s_waitcnt vmcnt(55)
    s_add_u32 m0, s38, 0
    s_add_u32 s29, s40, 0
    buffer_load_dwordx4 v12, s[12:15], s29 offen offset:0 sc1 lds
    buffer_load_dwordx4 v12, s[12:15], s29 offen offset:1024 sc1 lds
    buffer_load_dwordx4 v12, s[12:15], s29 offen offset:2048 sc1 lds
    buffer_load_dwordx4 v12, s[12:15], s29 offen offset:3072 sc1 lds
    s_add_u32 m0, s38, 4096
    s_add_u32 s29, s40, 4096
    buffer_load_dwordx4 v12, s[12:15], s29 offen offset:0 sc1 lds
    buffer_load_dwordx4 v12, s[12:15], s29 offen offset:1024 sc1 lds
    buffer_load_dwordx4 v12, s[12:15], s29 offen offset:2048 sc1 lds
    buffer_load_dwordx4 v12, s[12:15], s29 offen offset:3072 sc1 lds
    s_waitcnt vmcnt(55)
    s_add_u32 m0, s38, 8192
    s_add_u32 s29, s40, 8192
    buffer_load_dwordx4 v12, s[12:15], s29 offen offset:0 sc1 lds
    buffer_load_dwordx4 v12, s[12:15], s29 offen offset:1024 sc1 lds
    buffer_load_dwordx4 v12, s[12:15], s29 offen offset:2048 sc1 lds
    buffer_load_dwordx4 v12, s[12:15], s29 offen offset:3072 sc1 lds
    s_add_u32 m0, s38, 12288
    s_add_u32 s29, s40, 12288
    buffer_load_dwordx4 v12, s[12:15], s29 offen offset:0 sc1 lds
    buffer_load_dwordx4 v12, s[12:15], s29 offen offset:1024 sc1 lds
    buffer_load_dwordx4 v12, s[12:15], s29 offen offset:2048 sc1 lds
    buffer_load_dwordx4 v12, s[12:15], s29 offen offset:3072 sc1 lds
    s_waitcnt vmcnt(55)
    s_add_u32 m0, s38, 16384
    s_add_u32 s29, s40, 16384
    buffer_load_dwordx4 v12, s[12:15], s29 offen offset:0 sc1 lds
    buffer_load_dwordx4 v12, s[12:15], s29 offen offset:1024 sc1 lds
    buffer_load_dwordx4 v12, s[12:15], s29 offen offset:2048 sc1 lds
    buffer_load_dwordx4 v12, s[12:15], s29 offen offset:3072 sc1 lds
    s_add_u32 m0, s38, 20480
    s_add_u32 s29, s40, 20480
    buffer_load_dwordx4 v12, s[12:15], s29 offen offset:0 sc1 lds
    buffer_load_dwordx4 v12, s[12:15], s29 offen offset:1024 sc1 lds
    buffer_load_dwordx4 v12, s[12:15], s29 offen offset:2048 sc1 lds
    buffer_load_dwordx4 v12, s[12:15], s29 offen offset:3072 sc1 lds
    s_waitcnt vmcnt(55)
    s_add_u32 m0, s38, 24576
    s_add_u32 s29, s40, 24576
    buffer_load_dwordx4 v12, s[12:15], s29 offen offset:0 sc1 lds
    buffer_load_dwordx4 v12, s[12:15], s29 offen offset:1024 sc1 lds
    buffer_load_dwordx4 v12, s[12:15], s29 offen offset:2048 sc1 lds
    buffer_load_dwordx4 v12, s[12:15], s29 offen offset:3072 sc1 lds
    s_add_u32 m0, s38, 28672
    s_add_u32 s29, s40, 28672
    buffer_load_dwordx4 v12, s[12:15], s29 offen offset:0 sc1 lds
    buffer_load_dwordx4 v12, s[12:15], s29 offen offset:1024 sc1 lds
    buffer_load_dwordx4 v12, s[12:15], s29 offen offset:2048 sc1 lds
    buffer_load_dwordx4 v12, s[12:15], s29 offen offset:3072 sc1 lds
    s_waitcnt vmcnt(55)
    s_add_u32 m0, s38, 32768
    s_add_u32 s29, s40, 32768
    buffer_load_dwordx4 v12, s[12:15], s29 offen offset:0 sc1 lds
    buffer_load_dwordx4 v12, s[12:15], s29 offen offset:1024 sc1 lds
    buffer_load_dwordx4 v12, s[12:15], s29 offen offset:2048 sc1 lds
    buffer_load_dwordx4 v12, s[12:15], s29 offen offset:3072 sc1 lds
    s_add_u32 m0, s38, 36864
    s_add_u32 s29, s40, 36864
    buffer_load_dwordx4 v12, s[12:15], s29 offen offset:0 sc1 lds
    buffer_load_dwordx4 v12, s[12:15], s29 offen offset:1024 sc1 lds
    buffer_load_dwordx4 v12, s[12:15], s29 offen offset:2048 sc1 lds
    buffer_load_dwordx4 v12, s[12:15], s29 offen offset:3072 sc1 lds
    s_waitcnt vmcnt(20)
    s_cmp_ge_u32 s25, 3
    s_cbranch_scc1 L_publish
L_published:
    s_waitcnt vmcnt(0)
    s_barrier
    s_mov_b64 exec, 0xff
    buffer_load_dword v15, v14, s[12:15], s34 offen sc1
    s_mov_b32 s41, 262144
L_spin_kv3:
    s_waitcnt vmcnt(0)
    v_cmp_eq_u32 vcc, 0, v15
    s_cbranch_vccz L_got_kv3
    s_sleep 1
    buffer_load_dword v15, v14, s[12:15], s34 offen sc1
    s_sub_u32 s41, s41, 1
    s_cmp_lg_u32 s41, 0
    s_cbranch_scc1 L_spin_kv3
    s_waitcnt vmcnt(0)
L_got_kv3:
    s_mov_b64 exec, -1
    s_cmp_gt_u32 s25, 2
    s_cselect_b32 s29, 2, 3
    s_mul_i32 s29, s29, 40960
    s_add_u32 s40, s29, s39
    s_mov_b32 s38, 122880
    s_waitcnt vmcnt(55)
    s_add_u32 m0, s38, 0
    s_add_u32 s29, s40, 0
    buffer_load_dwordx4 v12, s[12:15], s29 offen offset:0 sc1 lds
    buffer_load_dwordx4 v12, s[12:15], s29 offen offset:1024 sc1 lds
    buffer_load_dwordx4 v12, s[12:15], s29 offen offset:2048 sc1 lds
    buffer_load_dwordx4 v12, s[12:15], s29 offen offset:3072 sc1 lds
    s_add_u32 m0, s38, 4096
    s_add_u32 s29, s40, 4096
    buffer_load_dwordx4 v12, s[12:15], s29 offen offset:0 sc1 lds
    buffer_load_dwordx4 v12, s[12:15], s29 offen offset:1024 sc1 lds
    buffer_load_dwordx4 v12, s[12:15], s29 offen offset:2048 sc1 lds
    buffer_load_dwordx4 v12, s[12:15], s29 offen offset:3072 sc1 lds
    s_waitcnt vmcnt(55)
    s_add_u32 m0, s38, 8192
    s_add_u32 s29, s40, 8192
    buffer_load_dwordx4 v12, s[12:15], s29 offen offset:0 sc1 lds
    buffer_load_dwordx4 v12, s[12:15], s29 offen offset:1024 sc1 lds
    buffer_load_dwordx4 v12, s[12:15], s29 offen offset:2048 sc1 lds
    buffer_load_dwordx4 v12, s[12:15], s29 offen offset:3072 sc1 lds
    s_add_u32 m0, s38, 12288
    s_add_u32 s29, s40, 12288
    buffer_load_dwordx4 v12, s[12:15], s29 offen offset:0 sc1 lds
    buffer_load_dwordx4 v12, s[12:15], s29 offen offset:1024 sc1 lds
    buffer_load_dwordx4 v12, s[12:15], s29 offen offset:2048 sc1 lds
    buffer_load_dwordx4 v12, s[12:15], s29 offen offset:3072 sc1 lds
    s_waitcnt vmcnt(55)
    s_add_u32 m0, s38, 16384
    s_add_u32 s29, s40, 16384
    buffer_load_dwordx4 v12, s[12:15], s29 offen offset:0 sc1 lds
    buffer_load_dwordx4 v12, s[12:15], s29 offen offset:1024 sc1 lds
    buffer_load_dwordx4 v12, s[12:15], s29 offen offset:2048 sc1 lds
    buffer_load_dwordx4 v12, s[12:15], s29 offen offset:3072 sc1 lds
    s_add_u32 m0, s38, 20480
    s_add_u32 s29, s40, 20480
    buffer_load_dwordx4 v12, s[12:15], s29 offen offset:0 sc1 lds
    buffer_load_dwordx4 v12, s[12:15], s29 offen offset:1024 sc1 lds
    buffer_load_dwordx4 v12, s[12:15], s29 offen offset:2048 sc1 lds
    buffer_load_dwordx4 v12, s[12:15], s29 offen offset:3072 sc1 lds
    s_waitcnt vmcnt(55)
    s_add_u32 m0, s38, 24576
    s_add_u32 s29, s40, 24576
    buffer_load_dwordx4 v12, s[12:15], s29 offen offset:0 sc1 lds
    buffer_load_dwordx4 v12, s[12:15], s29 offen offset:1024 sc1 lds
    buffer_load_dwordx4 v12, s[12:15], s29 offen offset:2048 sc1 lds
    buffer_load_dwordx4 v12, s[12:15], s29 offen offset:3072 sc1 lds
    s_add_u32 m0, s38, 28672
    s_add_u32 s29, s40, 28672
    buffer_load_dwordx4 v12, s[12:15], s29 offen offset:0 sc1 lds
    buffer_load_dwordx4 v12, s[12:15], s29 offen offset:1024 sc1 lds
    buffer_load_dwordx4 v12, s[12:15], s29 offen offset:2048 sc1 lds
    buffer_load_dwordx4 v12, s[12:15], s29 offen offset:3072 sc1 lds
    s_waitcnt vmcnt(55)
    s_add_u32 m0, s38, 32768
    s_add_u32 s29, s40, 32768
    buffer_load_dwordx4 v12, s[12:15], s29 offen offset:0 sc1 lds
    buffer_load_dwordx4 v12, s[12:15], s29 offen offset:1024 sc1 lds
    buffer_load_dwordx4 v12, s[12:15], s29 offen offset:2048 sc1 lds
    buffer_load_dwordx4 v12, s[12:15], s29 offen offset:3072 sc1 lds
    s_add_u32 m0, s38, 36864
    s_add_u32 s29, s40, 36864
    buffer_load_dwordx4 v12, s[12:15], s29 offen offset:0 sc1 lds
    buffer_load_dwordx4 v12, s[12:15], s29 offen offset:1024 sc1 lds
    buffer_load_dwordx4 v12, s[12:15], s29 offen offset:2048 sc1 lds
    buffer_load_dwordx4 v12, s[12:15], s29 offen offset:3072 sc1 lds
    s_cmp_gt_u32 s25, 3
    s_cselect_b32 s29, 3, 4
    s_mul_i32 s29, s29, 40960
    s_add_u32 s40, s29, s39
    s_mov_b32 s38, 0
    s_waitcnt vmcnt(55)
    s_add_u32 m0, s38, 0
    s_add_u32 s29, s40, 0
    buffer_load_dwordx4 v12, s[12:15], s29 offen offset:0 sc1 lds
    buffer_load_dwordx4 v12, s[12:15], s29 offen offset:1024 sc1 lds
    buffer_load_dwordx4 v12, s[12:15], s29 offen offset:2048 sc1 lds
    buffer_load_dwordx4 v12, s[12:15], s29 offen offset:3072 sc1 lds
    s_add_u32 m0, s38, 4096
    s_add_u32 s29, s40, 4096
    buffer_load_dwordx4 v12, s[12:15], s29 offen offset:0 sc1 lds
    buffer_load_dwordx4 v12, s[12:15], s29 offen offset:1024 sc1 lds
    buffer_load_dwordx4 v12, s[12:15], s29 offen offset:2048 sc1 lds
    buffer_load_dwordx4 v12, s[12:15], s29 offen offset:3072 sc1 lds
    s_waitcnt vmcnt(55)
    s_add_u32 m0, s38, 8192
    s_add_u32 s29, s40, 8192
    buffer_load_dwordx4 v12, s[12:15], s29 offen offset:0 sc1 lds
    buffer_load_dwordx4 v12, s[12:15], s29 offen offset:1024 sc1 lds
    buffer_load_dwordx4 v12, s[12:15], s29 offen offset:2048 sc1 lds
    buffer_load_dwordx4 v12, s[12:15], s29 offen offset:3072 sc1 lds
    s_add_u32 m0, s38, 12288
    s_add_u32 s29, s40, 12288
    buffer_load_dwordx4 v12, s[12:15], s29 offen offset:0 sc1 lds
    buffer_load_dwordx4 v12, s[12:15], s29 offen offset:1024 sc1 lds
    buffer_load_dwordx4 v12, s[12:15], s29 offen offset:2048 sc1 lds
    buffer_load_dwordx4 v12, s[12:15], s29 offen offset:3072 sc1 lds
    s_waitcnt vmcnt(55)
    s_add_u32 m0, s38, 16384
    s_add_u32 s29, s40, 16384
    buffer_load_dwordx4 v12, s[12:15], s29 offen offset:0 sc1 lds
    buffer_load_dwordx4 v12, s[12:15], s29 offen offset:1024 sc1 lds
    buffer_load_dwordx4 v12, s[12:15], s29 offen offset:2048 sc1 lds
    buffer_load_dwordx4 v12, s[12:15], s29 offen offset:3072 sc1 lds
    s_add_u32 m0, s38, 20480
    s_add_u32 s29, s40, 20480
    buffer_load_dwordx4 v12, s[12:15], s29 offen offset:0 sc1 lds
    buffer_load_dwordx4 v12, s[12:15], s29 offen offset:1024 sc1 lds
    buffer_load_dwordx4 v12, s[12:15], s29 offen offset:2048 sc1 lds
    buffer_load_dwordx4 v12, s[12:15], s29 offen offset:3072 sc1 lds
    s_waitcnt vmcnt(55)
    s_add_u32 m0, s38, 24576
    s_add_u32 s29, s40, 24576
    buffer_load_dwordx4 v12, s[12:15], s29 offen offset:0 sc1 lds
    buffer_load_dwordx4 v12, s[12:15], s29 offen offset:1024 sc1 lds
    buffer_load_dwordx4 v12, s[12:15], s29 offen offset:2048 sc1 lds
    buffer_load_dwordx4 v12, s[12:15], s29 offen offset:3072 sc1 lds
    s_add_u32 m0, s38, 28672
    s_add_u32 s29, s40, 28672
    buffer_load_dwordx4 v12, s[12:15], s29 offen offset:0 sc1 lds
    buffer_load_dwordx4 v12, s[12:15], s29 offen offset:1024 sc1 lds
    buffer_load_dwordx4 v12, s[12:15], s29 offen offset:2048 sc1 lds
    buffer_load_dwordx4 v12, s[12:15], s29 offen offset:3072 sc1 lds
    s_waitcnt vmcnt(55)
    s_add_u32 m0, s38, 32768
    s_add_u32 s29, s40, 32768
    buffer_load_dwordx4 v12, s[12:15], s29 offen offset:0 sc1 lds
    buffer_load_dwordx4 v12, s[12:15], s29 offen offset:1024 sc1 lds
    buffer_load_dwordx4 v12, s[12:15], s29 offen offset:2048 sc1 lds
    buffer_load_dwordx4 v12, s[12:15], s29 offen offset:3072 sc1 lds
    s_add_u32 m0, s38, 36864
    s_add_u32 s29, s40, 36864
    buffer_load_dwordx4 v12, s[12:15], s29 offen offset:0 sc1 lds
    buffer_load_dwordx4 v12, s[12:15], s29 offen offset:1024 sc1 lds
    buffer_load_dwordx4 v12, s[12:15], s29 offen offset:2048 sc1 lds
    buffer_load_dwordx4 v12, s[12:15], s29 offen offset:3072 sc1 lds
    s_waitcnt vmcnt(40)
    s_barrier
    s_lshl_b32 s29, s25, 5
    s_add_u32 s29, s29, s27
    s_mul_i32 s29, s29, 18432
    s_add_u32 s29, s29, 10485760
    s_lshl_b32 s40, s28, 10
    s_add_u32 s40, s40, s29
    v_mov_b32 v24, -1
    v_mov_b32 v25, -1
    v_mov_b32 v26, -1
    v_mov_b32 v27, -1
    v_lshrrev_b32 v4, 4, v1
    v_mul_u32_u24 v4, 36864, v4
    v_lshl_add_u32 v4, v3, 4, v4
    buffer_store_dwordx4 v[24:27], v12, s[12:15], s40 offen sc1
    s_add_u32 s40, s40, 36864
    buffer_store_dwordx4 v[24:27], v12, s[12:15], s40 offen sc1
    s_add_u32 s40, s40, 36864
    buffer_store_dwordx4 v[24:27], v12, s[12:15], s40 offen sc1
    s_add_u32 s40, s40, 36864
    buffer_store_dwordx4 v[24:27], v12, s[12:15], s40 offen sc1
    s_add_u32 s40, s40, 36864
    buffer_store_dwordx4 v[24:27], v12, s[12:15], s40 offen sc1
    s_add_u32 s40, s40, 36864
    buffer_store_dwordx4 v[24:27], v12, s[12:15], s40 offen sc1
    s_add_u32 s40, s40, 36864
    buffer_store_dwordx4 v[24:27], v12, s[12:15], s40 offen sc1
    s_add_u32 s40, s40, 36864
    buffer_store_dwordx4 v[24:27], v12, s[12:15], s40 offen sc1
    s_add_u32 s40, s40, 36864
    buffer_store_dwordx4 v[24:27], v12, s[12:15], s40 offen sc1
    s_add_u32 s40, s40, 36864
    buffer_store_dwordx4 v[24:27], v12, s[12:15], s40 offen sc1
    s_add_u32 s40, s40, 36864
    buffer_store_dwordx4 v[24:27], v12, s[12:15], s40 offen sc1
    s_add_u32 s40, s40, 36864
    buffer_store_dwordx4 v[24:27], v12, s[12:15], s40 offen sc1
    s_add_u32 s40, s40, 36864
    buffer_store_dwordx4 v[24:27], v12, s[12:15], s40 offen sc1
    s_add_u32 s40, s40, 36864
    buffer_store_dwordx4 v[24:27], v12, s[12:15], s40 offen sc1
    s_add_u32 s40, s40, 36864
    buffer_store_dwordx4 v[24:27], v12, s[12:15], s40 offen sc1
    s_add_u32 s40, s40, 36864
    buffer_store_dwordx4 v[24:27], v12, s[12:15], s40 offen sc1
    s_add_u32 s40, s40, 36864
    s_lshr_b32 s30, s28, 3
    s_lshl_b32 s30, s30, 10
    s_and_b32 s31, s28, 3
    s_lshl_b32 s31, s31, 8
    s_add_u32 s30, s30, s31
    s_bfe_u32 s31, s28, 0x10002
    s_lshl_b32 s31, s31, 3
    s_add_u32 s30, s30, s31
    s_add_u32 s30, s30, 16384
    s_add_u32 s40, s29, s30
    buffer_store_dwordx2 v[24:25], v4, s[12:15], s40 offen sc1
    s_add_u32 s40, s40, 147456
    buffer_store_dwordx2 v[24:25], v4, s[12:15], s40 offen sc1
    s_add_u32 s40, s40, 147456
    buffer_store_dwordx2 v[24:25], v4, s[12:15], s40 offen sc1
    s_add_u32 s40, s40, 147456
    buffer_store_dwordx2 v[24:25], v4, s[12:15], s40 offen sc1
    s_add_u32 s40, s40, 147456
    s_cmp_gt_u32 s25, 4
    s_cselect_b32 s29, 4, 5
    s_mul_i32 s29, s29, 40960
    s_add_u32 s40, s29, s39
    s_mov_b32 s38, 40960
    s_waitcnt vmcnt(55)
    s_add_u32 m0, s38, 0
    s_add_u32 s29, s40, 0
    buffer_load_dwordx4 v12, s[12:15], s29 offen offset:0 sc1 lds
    buffer_load_dwordx4 v12, s[12:15], s29 offen offset:1024 sc1 lds
    buffer_load_dwordx4 v12, s[12:15], s29 offen offset:2048 sc1 lds
    buffer_load_dwordx4 v12, s[12:15], s29 offen offset:3072 sc1 lds
    s_add_u32 m0, s38, 4096
    s_add_u32 s29, s40, 4096
    buffer_load_dwordx4 v12, s[12:15], s29 offen offset:0 sc1 lds
    buffer_load_dwordx4 v12, s[12:15], s29 offen offset:1024 sc1 lds
    buffer_load_dwordx4 v12, s[12:15], s29 offen offset:2048 sc1 lds
    buffer_load_dwordx4 v12, s[12:15], s29 offen offset:3072 sc1 lds
    s_waitcnt vmcnt(55)
    s_add_u32 m0, s38, 8192
    s_add_u32 s29, s40, 8192
    buffer_load_dwordx4 v12, s[12:15], s29 offen offset:0 sc1 lds
    buffer_load_dwordx4 v12, s[12:15], s29 offen offset:1024 sc1 lds
    buffer_load_dwordx4 v12, s[12:15], s29 offen offset:2048 sc1 lds
    buffer_load_dwordx4 v12, s[12:15], s29 offen offset:3072 sc1 lds
    s_add_u32 m0, s38, 12288
    s_add_u32 s29, s40, 12288
    buffer_load_dwordx4 v12, s[12:15], s29 offen offset:0 sc1 lds
    buffer_load_dwordx4 v12, s[12:15], s29 offen offset:1024 sc1 lds
    buffer_load_dwordx4 v12, s[12:15], s29 offen offset:2048 sc1 lds
    buffer_load_dwordx4 v12, s[12:15], s29 offen offset:3072 sc1 lds
    s_waitcnt vmcnt(55)
    s_add_u32 m0, s38, 16384
    s_add_u32 s29, s40, 16384
    buffer_load_dwordx4 v12, s[12:15], s29 offen offset:0 sc1 lds
    buffer_load_dwordx4 v12, s[12:15], s29 offen offset:1024 sc1 lds
    buffer_load_dwordx4 v12, s[12:15], s29 offen offset:2048 sc1 lds
    buffer_load_dwordx4 v12, s[12:15], s29 offen offset:3072 sc1 lds
    s_add_u32 m0, s38, 20480
    s_add_u32 s29, s40, 20480
    buffer_load_dwordx4 v12, s[12:15], s29 offen offset:0 sc1 lds
    buffer_load_dwordx4 v12, s[12:15], s29 offen offset:1024 sc1 lds
    buffer_load_dwordx4 v12, s[12:15], s29 offen offset:2048 sc1 lds
    buffer_load_dwordx4 v12, s[12:15], s29 offen offset:3072 sc1 lds
    s_waitcnt vmcnt(55)
    s_add_u32 m0, s38, 24576
    s_add_u32 s29, s40, 24576
    buffer_load_dwordx4 v12, s[12:15], s29 offen offset:0 sc1 lds
    buffer_load_dwordx4 v12, s[12:15], s29 offen offset:1024 sc1 lds
    buffer_load_dwordx4 v12, s[12:15], s29 offen offset:2048 sc1 lds
    buffer_load_dwordx4 v12, s[12:15], s29 offen offset:3072 sc1 lds
    s_add_u32 m0, s38, 28672
    s_add_u32 s29, s40, 28672
    buffer_load_dwordx4 v12, s[12:15], s29 offen offset:0 sc1 lds
    buffer_load_dwordx4 v12, s[12:15], s29 offen offset:1024 sc1 lds
    buffer_load_dwordx4 v12, s[12:15], s29 offen offset:2048 sc1 lds
    buffer_load_dwordx4 v12, s[12:15], s29 offen offset:3072 sc1 lds
    s_waitcnt vmcnt(55)
    s_add_u32 m0, s38, 32768
    s_add_u32 s29, s40, 32768
    buffer_load_dwordx4 v12, s[12:15], s29 offen offset:0 sc1 lds
    buffer_load_dwordx4 v12, s[12:15], s29 offen offset:1024 sc1 lds
    buffer_load_dwordx4 v12, s[12:15], s29 offen offset:2048 sc1 lds
    buffer_load_dwordx4 v12, s[12:15], s29 offen offset:3072 sc1 lds
    s_add_u32 m0, s38, 36864
    s_add_u32 s29, s40, 36864
    buffer_load_dwordx4 v12, s[12:15], s29 offen offset:0 sc1 lds
    buffer_load_dwordx4 v12, s[12:15], s29 offen offset:1024 sc1 lds
    buffer_load_dwordx4 v12, s[12:15], s29 offen offset:2048 sc1 lds
    buffer_load_dwordx4 v12, s[12:15], s29 offen offset:3072 sc1 lds
    s_waitcnt vmcnt(40)
    s_lshl_b32 s30, s25, 7
    s_lshl_b32 s29, s26, 2
    s_add_u32 s30, s30, s29
    s_add_u32 s30, s30, 15208448
    v_mov_b32 v15, 1
    s_mov_b64 exec, 1
    buffer_store_dword v15, v16, s[12:15], s30 offen sc1
    s_mov_b64 exec, -1
    s_barrier
    s_cmp_gt_u32 s25, 5
    s_cselect_b32 s29, 5, 6
    s_mul_i32 s29, s29, 40960
    s_add_u32 s40, s29, s39
    s_mov_b32 s38, 81920
    s_waitcnt vmcnt(55)
    s_add_u32 m0, s38, 0
    s_add_u32 s29, s40, 0
    buffer_load_dwordx4 v12, s[12:15], s29 offen offset:0 sc1 lds
    buffer_load_dwordx4 v12, s[12:15], s29 offen offset:1024 sc1 lds
    buffer_load_dwordx4 v12, s[12:15], s29 offen offset:2048 sc1 lds
    buffer_load_dwordx4 v12, s[12:15], s29 offen offset:3072 sc1 lds
    s_add_u32 m0, s38, 4096
    s_add_u32 s29, s40, 4096
    buffer_load_dwordx4 v12, s[12:15], s29 offen offset:0 sc1 lds
    buffer_load_dwordx4 v12, s[12:15], s29 offen offset:1024 sc1 lds
    buffer_load_dwordx4 v12, s[12:15], s29 offen offset:2048 sc1 lds
    buffer_load_dwordx4 v12, s[12:15], s29 offen offset:3072 sc1 lds
    s_waitcnt vmcnt(55)
    s_add_u32 m0, s38, 8192
    s_add_u32 s29, s40, 8192
    buffer_load_dwordx4 v12, s[12:15], s29 offen offset:0 sc1 lds
    buffer_load_dwordx4 v12, s[12:15], s29 offen offset:1024 sc1 lds
    buffer_load_dwordx4 v12, s[12:15], s29 offen offset:2048 sc1 lds
    buffer_load_dwordx4 v12, s[12:15], s29 offen offset:3072 sc1 lds
    s_add_u32 m0, s38, 12288
    s_add_u32 s29, s40, 12288
    buffer_load_dwordx4 v12, s[12:15], s29 offen offset:0 sc1 lds
    buffer_load_dwordx4 v12, s[12:15], s29 offen offset:1024 sc1 lds
    buffer_load_dwordx4 v12, s[12:15], s29 offen offset:2048 sc1 lds
    buffer_load_dwordx4 v12, s[12:15], s29 offen offset:3072 sc1 lds
    s_waitcnt vmcnt(55)
    s_add_u32 m0, s38, 16384
    s_add_u32 s29, s40, 16384
    buffer_load_dwordx4 v12, s[12:15], s29 offen offset:0 sc1 lds
    buffer_load_dwordx4 v12, s[12:15], s29 offen offset:1024 sc1 lds
    buffer_load_dwordx4 v12, s[12:15], s29 offen offset:2048 sc1 lds
    buffer_load_dwordx4 v12, s[12:15], s29 offen offset:3072 sc1 lds
    s_add_u32 m0, s38, 20480
    s_add_u32 s29, s40, 20480
    buffer_load_dwordx4 v12, s[12:15], s29 offen offset:0 sc1 lds
    buffer_load_dwordx4 v12, s[12:15], s29 offen offset:1024 sc1 lds
    buffer_load_dwordx4 v12, s[12:15], s29 offen offset:2048 sc1 lds
    buffer_load_dwordx4 v12, s[12:15], s29 offen offset:3072 sc1 lds
    s_waitcnt vmcnt(55)
    s_add_u32 m0, s38, 24576
    s_add_u32 s29, s40, 24576
    buffer_load_dwordx4 v12, s[12:15], s29 offen offset:0 sc1 lds
    buffer_load_dwordx4 v12, s[12:15], s29 offen offset:1024 sc1 lds
    buffer_load_dwordx4 v12, s[12:15], s29 offen offset:2048 sc1 lds
    buffer_load_dwordx4 v12, s[12:15], s29 offen offset:3072 sc1 lds
    s_add_u32 m0, s38, 28672
    s_add_u32 s29, s40, 28672
    buffer_load_dwordx4 v12, s[12:15], s29 offen offset:0 sc1 lds
    buffer_load_dwordx4 v12, s[12:15], s29 offen offset:1024 sc1 lds
    buffer_load_dwordx4 v12, s[12:15], s29 offen offset:2048 sc1 lds
    buffer_load_dwordx4 v12, s[12:15], s29 offen offset:3072 sc1 lds
    s_waitcnt vmcnt(55)
    s_add_u32 m0, s38, 32768
    s_add_u32 s29, s40, 32768
    buffer_load_dwordx4 v12, s[12:15], s29 offen offset:0 sc1 lds
    buffer_load_dwordx4 v12, s[12:15], s29 offen offset:1024 sc1 lds
    buffer_load_dwordx4 v12, s[12:15], s29 offen offset:2048 sc1 lds
    buffer_load_dwordx4 v12, s[12:15], s29 offen offset:3072 sc1 lds
    s_add_u32 m0, s38, 36864
    s_add_u32 s29, s40, 36864
    buffer_load_dwordx4 v12, s[12:15], s29 offen offset:0 sc1 lds
    buffer_load_dwordx4 v12, s[12:15], s29 offen offset:1024 sc1 lds
    buffer_load_dwordx4 v12, s[12:15], s29 offen offset:2048 sc1 lds
    buffer_load_dwordx4 v12, s[12:15], s29 offen offset:3072 sc1 lds
    s_waitcnt vmcnt(40)
    s_barrier
    v_lshlrev_b32 v5, 7, v1
    s_lshr_b32 s29, s2, 3
    s_mul_i32 s29, s29, 20736
    s_mov_b32 s16, s48
    s_and_b32 s17, s49, 0xffff
    s_mov_b32 s18, 663552
    s_add_u32 s30, s29, 0
    buffer_load_dword v28, v5, s[16:19], s30 offen
    s_add_u32 s30, s29, 8192
    buffer_load_dword v29, v5, s[16:19], s30 offen
    s_add_u32 s30, s29, 16384
    buffer_load_dword v30, v5, s[16:19], s30 offen
    s_mov_b32 s16, s54
    s_and_b32 s17, s55, 0xffff
    s_mov_b32 s18, 663552
    s_add_u32 s30, s29, 0
    buffer_load_dword v31, v5, s[16:19], s30 offen
    s_add_u32 s30, s29, 8192
    buffer_load_dword v32, v5, s[16:19], s30 offen
    s_add_u32 s30, s29, 16384
    buffer_load_dword v33, v5, s[16:19], s30 offen
    s_cmp_gt_u32 s25, 6
    s_cselect_b32 s29, 6, 7
    s_mul_i32 s29, s29, 40960
    s_add_u32 s40, s29, s39
    s_mov_b32 s38, 122880
    s_waitcnt vmcnt(55)
    s_add_u32 m0, s38, 0
    s_add_u32 s29, s40, 0
    buffer_load_dwordx4 v12, s[12:15], s29 offen offset:0 sc1 lds
    buffer_load_dwordx4 v12, s[12:15], s29 offen offset:1024 sc1 lds
    buffer_load_dwordx4 v12, s[12:15], s29 offen offset:2048 sc1 lds
    buffer_load_dwordx4 v12, s[12:15], s29 offen offset:3072 sc1 lds
    s_add_u32 m0, s38, 4096
    s_add_u32 s29, s40, 4096
    buffer_load_dwordx4 v12, s[12:15], s29 offen offset:0 sc1 lds
    buffer_load_dwordx4 v12, s[12:15], s29 offen offset:1024 sc1 lds
    buffer_load_dwordx4 v12, s[12:15], s29 offen offset:2048 sc1 lds
    buffer_load_dwordx4 v12, s[12:15], s29 offen offset:3072 sc1 lds
    s_waitcnt vmcnt(55)
    s_add_u32 m0, s38, 8192
    s_add_u32 s29, s40, 8192
    buffer_load_dwordx4 v12, s[12:15], s29 offen offset:0 sc1 lds
    buffer_load_dwordx4 v12, s[12:15], s29 offen offset:1024 sc1 lds
    buffer_load_dwordx4 v12, s[12:15], s29 offen offset:2048 sc1 lds
    buffer_load_dwordx4 v12, s[12:15], s29 offen offset:3072 sc1 lds
    s_add_u32 m0, s38, 12288
    s_add_u32 s29, s40, 12288
    buffer_load_dwordx4 v12, s[12:15], s29 offen offset:0 sc1 lds
    buffer_load_dwordx4 v12, s[12:15], s29 offen offset:1024 sc1 lds
    buffer_load_dwordx4 v12, s[12:15], s29 offen offset:2048 sc1 lds
    buffer_load_dwordx4 v12, s[12:15], s29 offen offset:3072 sc1 lds
    s_waitcnt vmcnt(55)
    s_add_u32 m0, s38, 16384
    s_add_u32 s29, s40, 16384
    buffer_load_dwordx4 v12, s[12:15], s29 offen offset:0 sc1 lds
    buffer_load_dwordx4 v12, s[12:15], s29 offen offset:1024 sc1 lds
    buffer_load_dwordx4 v12, s[12:15], s29 offen offset:2048 sc1 lds
    buffer_load_dwordx4 v12, s[12:15], s29 offen offset:3072 sc1 lds
    s_add_u32 m0, s38, 20480
    s_add_u32 s29, s40, 20480
    buffer_load_dwordx4 v12, s[12:15], s29 offen offset:0 sc1 lds
    buffer_load_dwordx4 v12, s[12:15], s29 offen offset:1024 sc1 lds
    buffer_load_dwordx4 v12, s[12:15], s29 offen offset:2048 sc1 lds
    buffer_load_dwordx4 v12, s[12:15], s29 offen offset:3072 sc1 lds
    s_waitcnt vmcnt(55)
    s_add_u32 m0, s38, 24576
    s_add_u32 s29, s40, 24576
    buffer_load_dwordx4 v12, s[12:15], s29 offen offset:0 sc1 lds
    buffer_load_dwordx4 v12, s[12:15], s29 offen offset:1024 sc1 lds
    buffer_load_dwordx4 v12, s[12:15], s29 offen offset:2048 sc1 lds
    buffer_load_dwordx4 v12, s[12:15], s29 offen offset:3072 sc1 lds
    s_add_u32 m0, s38, 28672
    s_add_u32 s29, s40, 28672
    buffer_load_dwordx4 v12, s[12:15], s29 offen offset:0 sc1 lds
    buffer_load_dwordx4 v12, s[12:15], s29 offen offset:1024 sc1 lds
    buffer_load_dwordx4 v12, s[12:15], s29 offen offset:2048 sc1 lds
    buffer_load_dwordx4 v12, s[12:15], s29 offen offset:3072 sc1 lds
    s_waitcnt vmcnt(55)
    s_add_u32 m0, s38, 32768
    s_add_u32 s29, s40, 32768
    buffer_load_dwordx4 v12, s[12:15], s29 offen offset:0 sc1 lds
    buffer_load_dwordx4 v12, s[12:15], s29 offen offset:1024 sc1 lds
    buffer_load_dwordx4 v12, s[12:15], s29 offen offset:2048 sc1 lds
    buffer_load_dwordx4 v12, s[12:15], s29 offen offset:3072 sc1 lds
    s_add_u32 m0, s38, 36864
    s_add_u32 s29, s40, 36864
    buffer_load_dwordx4 v12, s[12:15], s29 offen offset:0 sc1 lds
    buffer_load_dwordx4 v12, s[12:15], s29 offen offset:1024 sc1 lds
    buffer_load_dwordx4 v12, s[12:15], s29 offen offset:2048 sc1 lds
    buffer_load_dwordx4 v12, s[12:15], s29 offen offset:3072 sc1 lds
    s_waitcnt vmcnt(40)
    s_barrier
    s_mov_b32 exec_hi, 0x3fffff
    s_mov_b32 s16, s48
    s_and_b32 s17, s49, 0xffff
    s_mov_b32 s18, 663552
    s_mov_b32 m0, 0
    s_mov_b32 s40, 0
    s_waitcnt vmcnt(48)
    buffer_load_dwordx4 v13, s[16:19], s40 offen offset:0 lds
    buffer_load_dwordx4 v17, s[16:19], s40 offen offset:864 lds
    buffer_load_dwordx4 v18, s[16:19], s40 offen offset:1728 lds
    s_mov_b32 m0, 2592
    s_mov_b32 s40, 20736
    buffer_load_dwordx4 v13, s[16:19], s40 offen offset:0 lds
    buffer_load_dwordx4 v17, s[16:19], s40 offen offset:864 lds
    buffer_load_dwordx4 v18, s[16:19], s40 offen offset:1728 lds
    s_mov_b32 m0, 5184
    s_mov_b32 s40, 82944
    buffer_load_dwordx4 v13, s[16:19], s40 offen offset:0 lds
    buffer_load_dwordx4 v17, s[16:19], s40 offen offset:864 lds
    buffer_load_dwordx4 v18, s[16:19], s40 offen offset:1728 lds
    s_mov_b32 m0, 7776
    s_mov_b32 s40, 103680
    buffer_load_dwordx4 v13, s[16:19], s40 offen offset:0 lds
    buffer_load_dwordx4 v17, s[16:19], s40 offen offset:864 lds
    buffer_load_dwordx4 v18, s[16:19], s40 offen offset:1728 lds
    s_mov_b32 m0, 10368
    s_mov_b32 s40, 165888
    s_waitcnt vmcnt(48)
    buffer_load_dwordx4 v13, s[16:19], s40 offen offset:0 lds
    buffer_load_dwordx4 v17, s[16:19], s40 offen offset:864 lds
    buffer_load_dwordx4 v18, s[16:19], s40 offen offset:1728 lds
    s_mov_b32 m0, 12960
    s_mov_b32 s40, 186624
    buffer_load_dwordx4 v13, s[16:19], s40 offen offset:0 lds
    buffer_load_dwordx4 v17, s[16:19], s40 offen offset:864 lds
    buffer_load_dwordx4 v18, s[16:19], s40 offen offset:1728 lds
    s_mov_b32 m0, 15552
    s_mov_b32 s40, 248832
    buffer_load_dwordx4 v13, s[16:19], s40 offen offset:0 lds
    buffer_load_dwordx4 v17, s[16:19], s40 offen offset:864 lds
    buffer_load_dwordx4 v18, s[16:19], s40 offen offset:1728 lds
    s_mov_b32 m0, 18144
    s_mov_b32 s40, 269568
    buffer_load_dwordx4 v13, s[16:19], s40 offen offset:0 lds
    buffer_load_dwordx4 v17, s[16:19], s40 offen offset:864 lds
    buffer_load_dwordx4 v18, s[16:19], s40 offen offset:1728 lds
    s_mov_b32 m0, 20736
    s_mov_b32 s40, 373248
    s_waitcnt vmcnt(48)
    buffer_load_dwordx4 v13, s[16:19], s40 offen offset:0 lds
    buffer_load_dwordx4 v17, s[16:19], s40 offen offset:864 lds
    buffer_load_dwordx4 v18, s[16:19], s40 offen offset:1728 lds
    s_mov_b32 m0, 23328
    s_mov_b32 s40, 393984
    buffer_load_dwordx4 v13, s[16:19], s40 offen offset:0 lds
    buffer_load_dwordx4 v17, s[16:19], s40 offen offset:864 lds
    buffer_load_dwordx4 v18, s[16:19], s40 offen offset:1728 lds
    s_mov_b32 m0, 25920
    s_mov_b32 s40, 456192
    buffer_load_dwordx4 v13, s[16:19], s40 offen offset:0 lds
    buffer_load_dwordx4 v17, s[16:19], s40 offen offset:864 lds
    buffer_load_dwordx4 v18, s[16:19], s40 offen offset:1728 lds
    s_mov_b32 m0, 28512
    s_mov_b32 s40, 476928
    buffer_load_dwordx4 v13, s[16:19], s40 offen offset:0 lds
    buffer_load_dwordx4 v17, s[16:19], s40 offen offset:864 lds
    buffer_load_dwordx4 v18, s[16:19], s40 offen offset:1728 lds
    s_mov_b32 m0, 31104
    s_mov_b32 s40, 539136
    s_waitcnt vmcnt(48)
    buffer_load_dwordx4 v13, s[16:19], s40 offen offset:0 lds
    buffer_load_dwordx4 v17, s[16:19], s40 offen offset:864 lds
    buffer_load_dwordx4 v18, s[16:19], s40 offen offset:1728 lds
    s_mov_b32 m0, 33696
    s_mov_b32 s40, 559872
    buffer_load_dwordx4 v13, s[16:19], s40 offen offset:0 lds
    buffer_load_dwordx4 v17, s[16:19], s40 offen offset:864 lds
    buffer_load_dwordx4 v18, s[16:19], s40 offen offset:1728 lds
    s_mov_b32 m0, 36288
    s_mov_b32 s40, 41472
    buffer_load_dwordx4 v13, s[16:19], s40 offen offset:0 lds
    buffer_load_dwordx4 v17, s[16:19], s40 offen offset:864 lds
    buffer_load_dwordx4 v18, s[16:19], s40 offen offset:1728 lds
    s_waitcnt vmcnt(45)
    s_barrier
    s_mov_b32 s16, s48
    s_and_b32 s17, s49, 0xffff
    s_mov_b32 s18, 663552
    s_mov_b32 m0, 38880
    s_mov_b32 s40, 62208
    s_waitcnt vmcnt(48)
    buffer_load_dwordx4 v13, s[16:19], s40 offen offset:0 lds
    buffer_load_dwordx4 v17, s[16:19], s40 offen offset:864 lds
    buffer_load_dwordx4 v18, s[16:19], s40 offen offset:1728 lds
    s_mov_b32 m0, 41472
    s_mov_b32 s40, 124416
    buffer_load_dwordx4 v13, s[16:19], s40 offen offset:0 lds
    buffer_load_dwordx4 v17, s[16:19], s40 offen offset:864 lds
    buffer_load_dwordx4 v18, s[16:19], s40 offen offset:1728 lds
    s_mov_b32 m0, 44064
    s_mov_b32 s40, 145152
    buffer_load_dwordx4 v13, s[16:19], s40 offen offset:0 lds
    buffer_load_dwordx4 v17, s[16:19], s40 offen offset:864 lds
    buffer_load_dwordx4 v18, s[16:19], s40 offen offset:1728 lds
    s_mov_b32 m0, 46656
    s_mov_b32 s40, 207360
    buffer_load_dwordx4 v13, s[16:19], s40 offen offset:0 lds
    buffer_load_dwordx4 v17, s[16:19], s40 offen offset:864 lds
    buffer_load_dwordx4 v18, s[16:19], s40 offen offset:1728 lds
    s_mov_b32 m0, 49248
    s_mov_b32 s40, 228096
    s_waitcnt vmcnt(48)
    buffer_load_dwordx4 v13, s[16:19], s40 offen offset:0 lds
    buffer_load_dwordx4 v17, s[16:19], s40 offen offset:864 lds
    buffer_load_dwordx4 v18, s[16:19], s40 offen offset:1728 lds
    s_mov_b32 m0, 51840
    s_mov_b32 s40, 290304
    buffer_load_dwordx4 v13, s[16:19], s40 offen offset:0 lds
    buffer_load_dwordx4 v17, s[16:19], s40 offen offset:864 lds
    buffer_load_dwordx4 v18, s[16:19], s40 offen offset:1728 lds
    s_mov_b32 m0, 54432
    s_mov_b32 s40, 311040
    buffer_load_dwordx4 v13, s[16:19], s40 offen offset:0 lds
    buffer_load_dwordx4 v17, s[16:19], s40 offen offset:864 lds
    buffer_load_dwordx4 v18, s[16:19], s40 offen offset:1728 lds
    s_mov_b32 m0, 57024
    s_mov_b32 s40, 331776
    buffer_load_dwordx4 v13, s[16:19], s40 offen offset:0 lds
    buffer_load_dwordx4 v17, s[16:19], s40 offen offset:864 lds
    buffer_load_dwordx4 v18, s[16:19], s40 offen offset:1728 lds
    s_mov_b32 m0, 59616
    s_mov_b32 s40, 352512
    s_waitcnt vmcnt(48)
    buffer_load_dwordx4 v13, s[16:19], s40 offen offset:0 lds
    buffer_load_dwordx4 v17, s[16:19], s40 offen offset:864 lds
    buffer_load_dwordx4 v18, s[16:19], s40 offen offset:1728 lds
    s_mov_b32 m0, 62208
    s_mov_b32 s40, 414720
    buffer_load_dwordx4 v13, s[16:19], s40 offen offset:0 lds
    buffer_load_dwordx4 v17, s[16:19], s40 offen offset:864 lds
    buffer_load_dwordx4 v18, s[16:19], s40 offen offset:1728 lds
    s_mov_b32 m0, 64800
    s_mov_b32 s40, 435456
    buffer_load_dwordx4 v13, s[16:19], s40 offen offset:0 lds
    buffer_load_dwordx4 v17, s[16:19], s40 offen offset:864 lds
    buffer_load_dwordx4 v18, s[16:19], s40 offen offset:1728 lds
    s_mov_b32 m0, 67392
    s_mov_b32 s40, 497664
    buffer_load_dwordx4 v13, s[16:19], s40 offen offset:0 lds
    buffer_load_dwordx4 v17, s[16:19], s40 offen offset:864 lds
    buffer_load_dwordx4 v18, s[16:19], s40 offen offset:1728 lds
    s_mov_b32 m0, 69984
    s_mov_b32 s40, 518400
    s_waitcnt vmcnt(48)
    buffer_load_dwordx4 v13, s[16:19], s40 offen offset:0 lds
    buffer_load_dwordx4 v17, s[16:19], s40 offen offset:864 lds
    buffer_load_dwordx4 v18, s[16:19], s40 offen offset:1728 lds
    s_mov_b32 m0, 72576
    s_mov_b32 s40, 580608
    buffer_load_dwordx4 v13, s[16:19], s40 offen offset:0 lds
    buffer_load_dwordx4 v17, s[16:19], s40 offen offset:864 lds
    buffer_load_dwordx4 v18, s[16:19], s40 offen offset:1728 lds
    s_mov_b32 m0, 75168
    s_mov_b32 s40, 601344
    buffer_load_dwordx4 v13, s[16:19], s40 offen offset:0 lds
    buffer_load_dwordx4 v17, s[16:19], s40 offen offset:864 lds
    buffer_load_dwordx4 v18, s[16:19], s40 offen offset:1728 lds
    s_mov_b32 m0, 77760
    s_mov_b32 s40, 622080
    buffer_load_dwordx4 v13, s[16:19], s40 offen offset:0 lds
    buffer_load_dwordx4 v17, s[16:19], s40 offen offset:864 lds
    buffer_load_dwordx4 v18, s[16:19], s40 offen offset:1728 lds
    s_and_b32 s34, s2, 7
    s_lshl_b32 s34, s34, 7
    s_add_u32 s34, s34, 15208448
    s_mov_b32 exec_hi, 0
    buffer_load_dword v15, v14, s[12:15], s34 offen sc1
    s_mov_b32 s41, 262144
L_spin_o:
    s_waitcnt vmcnt(0)
    v_cmp_eq_u32 vcc, 0, v15
    s_cbranch_vccz L_got_o
    s_sleep 1
    buffer_load_dword v15, v14, s[12:15], s34 offen sc1
    s_sub_u32 s41, s41, 1
    s_cmp_lg_u32 s41, 0
    s_cbranch_scc1 L_spin_o
    s_waitcnt vmcnt(0)
L_got_o:
    s_mov_b32 exec_hi, 0x3fffff
    s_barrier
    s_mov_b32 s16, s48
    s_and_b32 s17, s49, 0xffff
    s_mov_b32 s18, 663552
    s_mov_b32 m0, 80352
    s_mov_b32 s40, 642816
    s_waitcnt vmcnt(48)
    buffer_load_dwordx4 v13, s[16:19], s40 offen offset:0 lds
    buffer_load_dwordx4 v17, s[16:19], s40 offen offset:864 lds
    buffer_load_dwordx4 v18, s[16:19], s40 offen offset:1728 lds
    s_mov_b32 s16, s54
    s_and_b32 s17, s55, 0xffff
    s_mov_b32 s18, 663552
    s_mov_b32 m0, 82944
    s_mov_b32 s40, 0
    s_waitcnt vmcnt(48)
    buffer_load_dwordx4 v13, s[16:19], s40 offen offset:0 lds
    buffer_load_dwordx4 v17, s[16:19], s40 offen offset:864 lds
    buffer_load_dwordx4 v18, s[16:19], s40 offen offset:1728 lds
    s_mov_b32 m0, 85536
    s_mov_b32 s40, 20736
    buffer_load_dwordx4 v13, s[16:19], s40 offen offset:0 lds
    buffer_load_dwordx4 v17, s[16:19], s40 offen offset:864 lds
    buffer_load_dwordx4 v18, s[16:19], s40 offen offset:1728 lds
    s_mov_b32 m0, 88128
    s_mov_b32 s40, 82944
    buffer_load_dwordx4 v13, s[16:19], s40 offen offset:0 lds
    buffer_load_dwordx4 v17, s[16:19], s40 offen offset:864 lds
    buffer_load_dwordx4 v18, s[16:19], s40 offen offset:1728 lds
    s_mov_b32 m0, 90720
    s_mov_b32 s40, 103680
    buffer_load_dwordx4 v13, s[16:19], s40 offen offset:0 lds
    buffer_load_dwordx4 v17, s[16:19], s40 offen offset:864 lds
    buffer_load_dwordx4 v18, s[16:19], s40 offen offset:1728 lds
    s_mov_b32 m0, 93312
    s_mov_b32 s40, 165888
    s_waitcnt vmcnt(48)
    buffer_load_dwordx4 v13, s[16:19], s40 offen offset:0 lds
    buffer_load_dwordx4 v17, s[16:19], s40 offen offset:864 lds
    buffer_load_dwordx4 v18, s[16:19], s40 offen offset:1728 lds
    s_mov_b32 m0, 95904
    s_mov_b32 s40, 186624
    buffer_load_dwordx4 v13, s[16:19], s40 offen offset:0 lds
    buffer_load_dwordx4 v17, s[16:19], s40 offen offset:864 lds
    buffer_load_dwordx4 v18, s[16:19], s40 offen offset:1728 lds
    s_mov_b32 m0, 98496
    s_mov_b32 s40, 248832
    buffer_load_dwordx4 v13, s[16:19], s40 offen offset:0 lds
    buffer_load_dwordx4 v17, s[16:19], s40 offen offset:864 lds
    buffer_load_dwordx4 v18, s[16:19], s40 offen offset:1728 lds
    s_mov_b32 m0, 101088
    s_mov_b32 s40, 269568
    buffer_load_dwordx4 v13, s[16:19], s40 offen offset:0 lds
    buffer_load_dwordx4 v17, s[16:19], s40 offen offset:864 lds
    buffer_load_dwordx4 v18, s[16:19], s40 offen offset:1728 lds
    s_mov_b32 m0, 103680
    s_mov_b32 s40, 373248
    s_waitcnt vmcnt(48)
    buffer_load_dwordx4 v13, s[16:19], s40 offen offset:0 lds
    buffer_load_dwordx4 v17, s[16:19], s40 offen offset:864 lds
    buffer_load_dwordx4 v18, s[16:19], s40 offen offset:1728 lds
    s_mov_b32 m0, 106272
    s_mov_b32 s40, 393984
    buffer_load_dwordx4 v13, s[16:19], s40 offen offset:0 lds
    buffer_load_dwordx4 v17, s[16:19], s40 offen offset:864 lds
    buffer_load_dwordx4 v18, s[16:19], s40 offen offset:1728 lds
    s_mov_b32 m0, 108864
    s_mov_b32 s40, 456192
    buffer_load_dwordx4 v13, s[16:19], s40 offen offset:0 lds
    buffer_load_dwordx4 v17, s[16:19], s40 offen offset:864 lds
    buffer_load_dwordx4 v18, s[16:19], s40 offen offset:1728 lds
    s_mov_b32 m0, 111456
    s_mov_b32 s40, 476928
    buffer_load_dwordx4 v13, s[16:19], s40 offen offset:0 lds
    buffer_load_dwordx4 v17, s[16:19], s40 offen offset:864 lds
    buffer_load_dwordx4 v18, s[16:19], s40 offen offset:1728 lds
    s_mov_b32 m0, 114048
    s_mov_b32 s40, 539136
    s_waitcnt vmcnt(48)
    buffer_load_dwordx4 v13, s[16:19], s40 offen offset:0 lds
    buffer_load_dwordx4 v17, s[16:19], s40 offen offset:864 lds
    buffer_load_dwordx4 v18, s[16:19], s40 offen offset:1728 lds
    s_mov_b32 m0, 116640
    s_mov_b32 s40, 559872
    buffer_load_dwordx4 v13, s[16:19], s40 offen offset:0 lds
    buffer_load_dwordx4 v17, s[16:19], s40 offen offset:864 lds
    buffer_load_dwordx4 v18, s[16:19], s40 offen offset:1728 lds
    s_mov_b32 m0, 119232
    s_mov_b32 s40, 41472
    buffer_load_dwordx4 v13, s[16:19], s40 offen offset:0 lds
    buffer_load_dwordx4 v17, s[16:19], s40 offen offset:864 lds
    buffer_load_dwordx4 v18, s[16:19], s40 offen offset:1728 lds
    s_mov_b32 m0, 121824
    s_mov_b32 s40, 62208
    buffer_load_dwordx4 v13, s[16:19], s40 offen offset:0 lds
    s_barrier
    s_mov_b32 s16, s54
    s_and_b32 s17, s55, 0xffff
    s_mov_b32 s18, 663552
    s_mov_b32 m0, 122688
    s_mov_b32 s40, 69120
    s_waitcnt vmcnt(48)
    buffer_load_dwordx4 v13, s[16:19], s40 offen offset:0 lds
    buffer_load_dwordx4 v17, s[16:19], s40 offen offset:864 lds
    s_mov_b32 m0, 124416
    s_mov_b32 s40, 124416
    buffer_load_dwordx4 v13, s[16:19], s40 offen offset:0 lds
    buffer_load_dwordx4 v17, s[16:19], s40 offen offset:864 lds
    buffer_load_dwordx4 v18, s[16:19], s40 offen offset:1728 lds
    s_mov_b32 m0, 127008
    s_mov_b32 s40, 145152
    buffer_load_dwordx4 v13, s[16:19], s40 offen offset:0 lds
    buffer_load_dwordx4 v17, s[16:19], s40 offen offset:864 lds
    buffer_load_dwordx4 v18, s[16:19], s40 offen offset:1728 lds
    s_mov_b32 m0, 129600
    s_mov_b32 s40, 207360
    buffer_load_dwordx4 v13, s[16:19], s40 offen offset:0 lds
    buffer_load_dwordx4 v17, s[16:19], s40 offen offset:864 lds
    buffer_load_dwordx4 v18, s[16:19], s40 offen offset:1728 lds
    s_mov_b32 m0, 132192
    s_mov_b32 s40, 228096
    buffer_load_dwordx4 v13, s[16:19], s40 offen offset:0 lds
    s_mov_b32 m0, 143424
    s_mov_b32 s40, 359424
    s_waitcnt vmcnt(48)
    buffer_load_dwordx4 v13, s[16:19], s40 offen offset:0 lds
    buffer_load_dwordx4 v17, s[16:19], s40 offen offset:864 lds
    s_mov_b32 m0, 145152
    s_mov_b32 s40, 414720
    buffer_load_dwordx4 v13, s[16:19], s40 offen offset:0 lds
    buffer_load_dwordx4 v17, s[16:19], s40 offen offset:864 lds
    buffer_load_dwordx4 v18, s[16:19], s40 offen offset:1728 lds
    s_mov_b32 m0, 147744
    s_mov_b32 s40, 435456
    buffer_load_dwordx4 v13, s[16:19], s40 offen offset:0 lds
    buffer_load_dwordx4 v17, s[16:19], s40 offen offset:864 lds
    buffer_load_dwordx4 v18, s[16:19], s40 offen offset:1728 lds
    s_mov_b32 m0, 150336
    s_mov_b32 s40, 497664
    buffer_load_dwordx4 v13, s[16:19], s40 offen offset:0 lds
    buffer_load_dwordx4 v17, s[16:19], s40 offen offset:864 lds
    buffer_load_dwordx4 v18, s[16:19], s40 offen offset:1728 lds
    s_barrier
    s_mov_b32 s16, s54
    s_and_b32 s17, s55, 0xffff
    s_mov_b32 s18, 663552
    s_mov_b32 m0, 133056
    s_mov_b32 s40, 235008
    s_waitcnt vmcnt(48)
    buffer_load_dwordx4 v13, s[16:19], s40 offen offset:0 lds
    buffer_load_dwordx4 v17, s[16:19], s40 offen offset:864 lds
    s_mov_b32 m0, 134784
    s_mov_b32 s40, 290304
    buffer_load_dwordx4 v13, s[16:19], s40 offen offset:0 lds
    buffer_load_dwordx4 v17, s[16:19], s40 offen offset:864 lds
    buffer_load_dwordx4 v18, s[16:19], s40 offen offset:1728 lds
    s_mov_b32 m0, 137376
    s_mov_b32 s40, 311040
    buffer_load_dwordx4 v13, s[16:19], s40 offen offset:0 lds
    s_mov_b32 m0, 152928
    s_mov_b32 s40, 518400
    buffer_load_dwordx4 v13, s[16:19], s40 offen offset:0 lds
    buffer_load_dwordx4 v17, s[16:19], s40 offen offset:864 lds
    buffer_load_dwordx4 v18, s[16:19], s40 offen offset:1728 lds
    s_mov_b32 m0, 155520
    s_mov_b32 s40, 580608
    buffer_load_dwordx4 v13, s[16:19], s40 offen offset:0 lds
    buffer_load_dwordx4 v17, s[16:19], s40 offen offset:864 lds
    buffer_load_dwordx4 v18, s[16:19], s40 offen offset:1728 lds
    s_waitcnt vmcnt(35)
    s_barrier
    s_mov_b32 s16, s54
    s_and_b32 s17, s55, 0xffff
    s_mov_b32 s18, 663552
    s_mov_b32 m0, 138240
    s_mov_b32 s40, 317952
    s_waitcnt vmcnt(48)
    buffer_load_dwordx4 v13, s[16:19], s40 offen offset:0 lds
    buffer_load_dwordx4 v17, s[16:19], s40 offen offset:864 lds
    s_mov_b32 m0, 139968
    s_mov_b32 s40, 331776
    buffer_load_dwordx4 v13, s[16:19], s40 offen offset:0 lds
    buffer_load_dwordx4 v17, s[16:19], s40 offen offset:864 lds
    buffer_load_dwordx4 v18, s[16:19], s40 offen offset:1728 lds
    s_mov_b32 m0, 142560
    s_mov_b32 s40, 352512
    buffer_load_dwordx4 v13, s[16:19], s40 offen offset:0 lds
    s_mov_b32 m0, 158112
    s_mov_b32 s40, 601344
    buffer_load_dwordx4 v13, s[16:19], s40 offen offset:0 lds
    buffer_load_dwordx4 v17, s[16:19], s40 offen offset:864 lds
    buffer_load_dwordx4 v18, s[16:19], s40 offen offset:1728 lds
    s_mov_b32 m0, 160704
    s_mov_b32 s40, 622080
    buffer_load_dwordx4 v13, s[16:19], s40 offen offset:0 lds
    buffer_load_dwordx4 v17, s[16:19], s40 offen offset:864 lds
    buffer_load_dwordx4 v18, s[16:19], s40 offen offset:1728 lds
    s_mov_b32 exec_lo, 0x3ffff
    s_mov_b32 exec_hi, 0x0
    s_mov_b32 m0, 163296
    s_mov_b32 s40, 642816
    buffer_load_dwordx4 v13, s[16:19], s40 offen lds
    s_barrier
    s_waitcnt vmcnt(56)
    s_mov_b32 exec_lo, 0xffffffff
    s_mov_b32 exec_hi, 0x3fffff
    s_mov_b32 m0, 0
    s_mov_b32 s40, 645120
    buffer_load_dwordx4 v13, s[16:19], s40 offen lds
    s_mov_b32 exec_lo, 0xffffffff
    s_mov_b32 exec_hi, 0x3fffff
    s_mov_b32 m0, 864
    s_mov_b32 s40, 652032
    buffer_load_dwordx4 v13, s[16:19], s40 offen lds
    s_mov_b32 exec_lo, 0xffffffff
    s_mov_b32 exec_hi, 0xf
    s_mov_b32 m0, 1728
    s_mov_b32 s40, 658944
    buffer_load_dwordx4 v13, s[16:19], s40 offen lds
    s_waitcnt vmcnt(0)
    s_barrier
    s_endpgm
L_ld_first:
    s_waitcnt vmcnt(56)
    s_cmp_lg_u32 s2, 0
    s_cbranch_scc1 L_ld_second
    v_mov_b32 v24, 0
    v_mov_b32 v25, 0
    v_mov_b32 v26, 0
    v_mov_b32 v27, 0
    s_mov_b32 s29, 15204352
    buffer_store_dwordx4 v[24:27], v12, s[12:15], s29 offen offset:0 sc1
    buffer_store_dwordx4 v[24:27], v12, s[12:15], s29 offen offset:1024 sc1
    buffer_store_dwordx4 v[24:27], v12, s[12:15], s29 offen offset:2048 sc1
    buffer_store_dwordx4 v[24:27], v12, s[12:15], s29 offen offset:3072 sc1
    s_mov_b32 s29, 15208448
    buffer_store_dwordx4 v[24:27], v12, s[12:15], s29 offen sc1
    s_branch L_ld_second
L_ld_ready:
    v_mov_b32 v15, 1
    s_mov_b64 exec, 1
    buffer_store_dword v15, v16, s[20:23], 0 offen sc1
    s_mov_b64 exec, -1
    s_branch L_ld_second
L_compute:
    s_cmp_lt_u32 s2, 128
    s_cbranch_scc1 L_nopf
    s_sub_u32 s29, s2, 128
    s_lshl_b32 s29, s29, 3
    s_add_u32 s29, s29, s24
    s_mul_i32 s30, s29, 2048
    s_mul_i32 s29, s29, 2304
    v_lshlrev_b32 v4, 7, v1
    s_waitcnt lgkmcnt(0)
    s_mov_b32 s4, s44
    s_and_b32 s5, s45, 0xffff
    s_mov_b32 s6, 2359296
    s_mov_b32 s7, 0x00020000
    s_mov_b32 s8, s46
    s_and_b32 s9, s47, 0xffff
    s_mov_b32 s10, 1990656
    s_mov_b32 s11, 0x00020000
    s_mov_b32 s16, s52
    s_and_b32 s17, s53, 0xffff
    s_mov_b32 s18, 1990656
    s_mov_b32 s19, 0x00020000
    s_mov_b32 exec_lo, 0xffff
    s_mov_b32 exec_hi, 0x0
    buffer_load_dword v155, v4, s[8:11], s30 offen
    buffer_load_dword v156, v4, s[16:19], s30 offen
    s_mov_b32 exec_lo, 0x3ffff
    s_mov_b32 exec_hi, 0x0
    buffer_load_dword v159, v4, s[4:7], s29 offen
    s_mov_b64 exec, -1
L_nopf:
    s_lshr_b32 s31, s24, 2
    s_and_b32 s32, s24, 3
    s_lshl_b32 s29, s32, 1
    s_add_u32 s30, s29, s31
    s_lshl_b32 s30, s30, 12
    s_add_u32 s30, s30, 57344
    v_lshrrev_b32 v4, 1, v3
    v_xor_b32 v4, v4, v2
    v_lshlrev_b32 v5, 7, v3
    v_lshl_add_u32 v6, v4, 4, v5
    v_xor_b32 v4, 4, v4
    v_lshl_add_u32 v7, v4, 4, v5
    v_add_u32 v133, s30, v6
    v_add_u32 v134, s30, v7
    s_xor_b32 s30, s30, 4096
    v_add_u32 v135, s30, v6
    v_add_u32 v136, s30, v7
    v_add_u32 v137, 65536, v133
    v_add_u32 v138, 65536, v134
    v_add_u32 v139, 65536, v135
    v_add_u32 v140, 65536, v136
    v_bfe_u32 v4, v1, 2, 2
    v_and_b32 v5, 3, v1
    v_and_b32 v6, 1, v2
    v_lshlrev_b32 v6, 2, v6
    v_or_b32 v6, v6, v4
    v_lshlrev_b32 v6, 1, v6
    v_lshl_add_u32 v7, v2, 3, v4
    v_lshlrev_b32 v7, 8, v7
    v_add_u32 v7, 8192, v7
    s_mul_i32 s29, s31, 5
    v_add_u32 v8, s29, v5
    v_lshrrev_b32 v9, 1, v8
    v_xor_b32 v9, v9, v6
    v_lshl_add_u32 v9, v9, 4, v7
    v_and_b32 v10, 1, v8
    v_lshl_add_u32 v128, v10, 3, v9
    v_add_u32 v8, 10, v8
    v_lshrrev_b32 v9, 1, v8
    v_xor_b32 v9, v9, v6
    v_lshl_add_u32 v9, v9, 4, v7
    v_and_b32 v10, 1, v8
    v_lshl_add_u32 v129, v10, 3, v9
    v_add_u32 v8, 11, v8
    v_lshrrev_b32 v9, 1, v8
    v_xor_b32 v9, v9, v6
    v_lshl_add_u32 v9, v9, 4, v7
    v_and_b32 v10, 1, v8
    v_lshl_add_u32 v130, v10, 3, v9
    v_lshlrev_b32 v8, 3, v5
    s_mov_b32 s29, 0x1b190e04
    v_lshrrev_b32 v8, v8, s29
    v_and_b32 v8, 0xff, v8
    v_lshrrev_b32 v9, 1, v8
    v_xor_b32 v9, v9, v6
    v_lshl_add_u32 v9, v9, 4, v7
    v_and_b32 v10, 1, v8
    v_lshl_add_u32 v131, v10, 3, v9
    s_lshl_b32 s29, s41, 7
    s_add_u32 s29, s29, 155648
    v_lshlrev_b32 v132, 4, v2
    v_add_u32 v132, s29, v132
    s_mov_b32 s42, 0xf000f000
    s_mov_b32 s43, 0xf000f000
    v_and_b32 v143, 7, v3
    v_or_b32 v143, 0x0c0c0c00, v143
    s_mov_b32 s41, 0x70f060e
    v_mov_b32 v12, 0x50d040c
    v_perm_b32 v13, s41, v12, v143
    s_mov_b32 s41, 0x13031202
    v_mov_b32 v12, 0x11011000
    v_cmp_gt_u32 vcc, 8, v3
    v_perm_b32 v143, s41, v12, v143
    s_nop 0
    v_cndmask_b32 v143, v143, v13, vcc
    s_mul_i32 s29, s32, 5120
    s_mov_b32 s30, s31
    s_mul_i32 s32, s30, 20480
    s_add_u32 s32, s32, s29
    s_xor_b32 s31, s30, 1
    v_lshlrev_b32 v6, 4, v1
    s_lshl_b32 s36, s30, 10
    s_add_u32 s36, s36, s32
    v_add_u32 v141, s36, v6
    s_lshl_b32 s36, s31, 10
    s_add_u32 s36, s36, s32
    v_add_u32 v142, s36, v6
    v_lshrrev_b32 v4, 1, v2
    v_and_b32 v5, 1, v2
    v_mul_u32_u24 v6, 320, v4
    v_lshl_add_u32 v6, v5, 3, v6
    v_lshl_add_u32 v6, v143, 4, v6
    s_add_u32 s32, s32, 2048
    s_mul_i32 s36, s31, 1280
    s_add_u32 s36, s36, s32
    v_add_u32 v144, s36, v6
    s_mul_i32 s36, s30, 1280
    s_add_u32 s41, s36, s32
    v_add_u32 v143, s41, v6
    s_add_u32 s36, s36, s29
    s_add_u32 s36, s36, 2048
    v_lshrrev_b32 v4, 3, v3
    v_mul_u32_u24 v4, 320, v4
    v_and_b32 v5, 7, v3
    v_lshl_add_u32 v4, v5, 1, v4
    v_add_u32 v4, s36, v4
    s_lshl_b32 s30, s30, 3
    s_add_u32 s30, s30, s29
    s_add_u32 s30, s30, 4608
    v_lshlrev_b32 v5, 4, v3
    v_add_u32 v5, s30, v5
    v_add_u32 v6, 122880, v5
    v_cmp_eq_u32 vcc, 1, v2
    v_add_u32 v7, 4, v6
    s_nop 0
    v_cndmask_b32 v6, v6, v5, vcc
    v_cmp_eq_u32 vcc, 2, v2
    v_mov_b32 v148, 1.0
    s_nop 0
    v_cndmask_b32 v6, v6, v4, vcc
    v_cmp_eq_u32 vcc, 3, v2
    v_mov_b32 v5, 0x3eae1a93
    s_nop 0
    v_cndmask_b32 v145, v6, v7, vcc
    v_cmp_eq_u32 vcc, 0, v2
    v_bfe_u32 v4, v1, 2, 1
    v_mul_u32_u24 v4, 20480, v4
    v_cndmask_b32 v148, v148, v5, vcc
    v_and_b32 v5, 3, v1
    v_mul_u32_u24 v5, 320, v5
    v_bfe_u32 v6, v1, 3, 1
    v_mul_u32_u24 v6, 48, v6
    v_add3_u32 v4, v4, v5, v6
    s_add_u32 s36, s36, 128
    v_add_u32 v146, s36, v4
    v_lshrrev_b32 v4, 5, v1
    v_mul_u32_u24 v4, 20480, v4
    v_and_b32 v5, 31, v1
    v_lshl_add_u32 v4, v5, 4, v4
    s_add_u32 s30, s30, 4
    v_add_u32 v147, s30, v4
    s_mov_b32 s36, 0x3eae1a93
    s_waitcnt lgkmcnt(0)
    s_mov_b32 s12, s62
    s_and_b32 s13, s63, 0xffff
    s_mov_b32 s14, 15209472
    s_mov_b32 s15, 0x00020000
    s_mov_b32 s20, s58
    s_and_b32 s21, s59, 0xffff
    s_mov_b32 s22, 2359296
    s_mov_b32 s23, 0x00020000
    s_lshr_b32 s29, s24, 2
    s_mul_i32 s29, s29, 20480
    v_lshlrev_b32 v4, 4, v1
    v_add_u32 v160, s29, v4
    v_and_b32 v7, 31, v1
    v_lshlrev_b32 v4, 4, v7
    s_add_u32 s30, s29, 4608
    v_add_u32 v161, s30, v4
    v_min_u32 v7, 19, v7
    v_lshrrev_b32 v4, 2, v7
    v_lshlrev_b32 v4, 3, v4
    s_mov_b32 s31, 0x1004000c
    v_lshrrev_b32 v6, v4, s31
    v_and_b32 v6, 0xff, v6
    v_and_b32 v4, 3, v7
    v_add_u32 v6, v6, v4
    v_add_u32 v4, 1, v4
    v_and_b32 v4, 3, v4
    v_or_b32 v4, 8, v4
    v_cmp_gt_u32 vcc, 16, v7
    v_lshrrev_b32 v5, 5, v1
    v_mul_u32_u24 v5, 20, v5
    v_cndmask_b32 v4, v4, v6, vcc
    v_add_u32 v4, v4, v5
    s_add_u32 s30, s29, 2048
    v_lshlrev_b32 v4, 4, v4
    v_add_u32 v162, s30, v4
    s_and_b32 s66, s24, 3
    s_mul_i32 s66, s66, 5120
    s_add_u32 s66, s66, 122880
    s_and_b32 s38, s24, 3
    s_lshr_b32 s64, s24, 2
    s_and_b32 s29, s2, 7
    s_lshl_b32 s29, s29, 2
    s_bfe_u32 s30, s2, 0x20003
    s_add_u32 s29, s29, s30
    s_lshl_b32 s29, s29, 2
    s_add_u32 s40, s29, s38
    s_mul_i32 s29, s64, 82944
    v_lshrrev_b32 v8, 4, v1
    v_bfe_u32 v9, v1, 2, 2
    v_and_b32 v4, 3, v1
    v_lshlrev_b32 v4, 3, v4
    v_and_b32 v5, 1, v8
    v_lshl_add_u32 v5, v5, 2, v9
    v_mul_u32_u24 v5, 288, v5
    v_add_u32 v5, v5, v4
    v_lshrrev_b32 v6, 1, v8
    v_mul_u32_u24 v7, 2880, v6
    v_add3_u32 v163, v5, v7, s29
    v_add_u32 v164, 41472, v163
    v_add_u32 v165, 77760, v163
    v_and_b32 v6, s64, v6
    v_cmp_eq_u32 vcc, 1, v6
    v_mul_u32_u24 v7, 5184, v8
    v_add_u32 v6, 16, v9
    v_cndmask_b32 v165, v165, v5, vcc
    v_mul_u32_u24 v5, 144, v6
    v_add3_u32 v7, v7, v4, v5
    v_add_u32 v166, s29, v7
    s_lshr_b32 s30, s2, 5
    s_mul_i32 s30, s30, 144
    s_mul_i32 s29, s40, 18432
    s_add_u32 s29, s29, s30
    v_and_b32 v6, 15, v1
    v_mul_u32_u24 v6, 1152, v6
    v_add_u32 v6, s29, v6
    v_lshl_add_u32 v158, v8, 3, v6
    v_lshrrev_b32 v9, 5, v1
    v_lshl_add_u32 v6, v9, 4, v6
    v_and_b32 v8, 1, v8
    v_lshl_add_u32 v157, v8, 5, v6
    s_lshl_b32 s29, s40, 1
    s_add_u32 s29, s29, s64
    s_mul_i32 s29, s29, 18432
    s_add_u32 s65, s29, 10485760
    s_add_u32 s67, s65, 4096
    s_add_u32 s70, s65, 8192
    s_add_u32 s71, s65, 12288
    s_add_u32 s3, s65, 16384
    s_and_b32 s29, s24, 3
    s_lshl_b32 s30, s25, 2
    s_add_u32 s29, s29, s30
    s_lshl_b32 s29, s29, 3
    s_add_u32 s29, s29, s27
    s_mul_i32 s29, s29, 18432
    s_add_u32 s29, s29, 10485760
    s_lshr_b32 s32, s24, 2
    s_lshl_b32 s30, s28, 1
    s_add_u32 s30, s30, s32
    s_lshl_b32 s30, s30, 9
    s_add_u32 s33, s29, s30
    s_xor_b32 s30, s32, 1
    s_mul_i32 s30, s30, 73728
    s_add_u32 s34, s33, s30
    s_mul_i32 s30, s32, 73728
    s_add_u32 s33, s33, s30
    v_bfe_u32 v2, v1, 4, 1
    v_mul_u32_u24 v2, 36864, v2
    v_lshrrev_b32 v3, 5, v1
    v_lshl_add_u32 v2, v3, 8, v2
    v_and_b32 v4, 15, v1
    v_lshl_add_u32 v2, v4, 4, v2
    s_lshl_b32 s32, s32, 2
    s_add_u32 s29, s29, s32
    s_lshr_b32 s30, s28, 3
    s_lshl_b32 s30, s30, 10
    s_and_b32 s31, s28, 3
    s_lshl_b32 s31, s31, 8
    s_add_u32 s30, s30, s31
    s_bfe_u32 s31, s28, 0x10002
    s_lshl_b32 s31, s31, 3
    s_add_u32 s30, s30, s31
    s_add_u32 s30, s30, 16384
    s_add_u32 s35, s29, s30
    v_lshrrev_b32 v3, 4, v1
    s_lshr_b32 s32, s32, 1
    v_xor_b32 v3, s32, v3
    v_mul_u32_u24 v3, 36864, v3
    v_lshl_add_u32 v3, v4, 4, v3
    s_barrier
    ds_read_b64_tr_b16 v[64:65], v128 offset:0
    ds_read_b64_tr_b16 v[66:67], v128 offset:1024
    ds_read_b128 v[96:99], v133 offset:32768
    ds_read_b128 v[100:103], v133 offset:34816
    ds_read_b128 v[104:107], v135 offset:32768
    ds_read_b128 v[108:111], v135 offset:34816
    ds_read_b64_tr_b16 v[68:69], v129 offset:0
    ds_read_b64_tr_b16 v[70:71], v129 offset:1024
    ds_read_b64_tr_b16 v[72:73], v130 offset:0
    ds_read_b64_tr_b16 v[74:75], v130 offset:1024
    ds_read_b64_tr_b16 v[76:77], v131 offset:0
    ds_read_b64_tr_b16 v[78:79], v131 offset:1024
    s_mov_b64 exec, s[42:43]
    ds_read_b128 v[76:79], v132 offset:0
    s_mov_b64 exec, -1
    s_waitcnt lgkmcnt(10)
    v_mfma_f32_16x16x32_bf16 v[8:11], v[64:67], v[96:99], 0
    s_waitcnt lgkmcnt(9)
    v_mfma_f32_16x16x32_bf16 v[12:15], v[64:67], v[100:103], 0
    s_waitcnt lgkmcnt(8)
    v_mfma_f32_16x16x32_bf16 v[16:19], v[64:67], v[104:107], 0
    s_waitcnt lgkmcnt(7)
    v_mfma_f32_16x16x32_bf16 v[20:23], v[64:67], v[108:111], 0
    s_waitcnt lgkmcnt(5)
    v_mfma_f32_16x16x32_bf16 v[24:27], v[68:71], v[96:99], 0
    v_mfma_f32_16x16x32_bf16 v[28:31], v[68:71], v[100:103], 0
    ds_read_b64_tr_b16 v[80:81], v128 offset:8192
    ds_read_b64_tr_b16 v[82:83], v128 offset:9216
    v_mfma_f32_16x16x32_bf16 v[32:35], v[68:71], v[104:107], 0
    ds_read_b128 v[112:115], v134 offset:32768
    v_mfma_f32_16x16x32_bf16 v[36:39], v[68:71], v[108:111], 0
    ds_read_b128 v[116:119], v134 offset:34816
    s_waitcnt lgkmcnt(7)
    v_mfma_f32_16x16x32_bf16 v[40:43], v[96:99], v[72:75], 0
    ds_read_b128 v[120:123], v136 offset:32768
    v_mfma_f32_16x16x32_bf16 v[44:47], v[100:103], v[72:75], 0
    ds_read_b128 v[124:127], v136 offset:34816
    v_mfma_f32_16x16x32_bf16 v[48:51], v[104:107], v[72:75], 0
    ds_read_b64_tr_b16 v[84:85], v129 offset:8192
    ds_read_b64_tr_b16 v[86:87], v129 offset:9216
    v_mfma_f32_16x16x32_bf16 v[52:55], v[108:111], v[72:75], 0
    ds_read_b64_tr_b16 v[88:89], v130 offset:8192
    ds_read_b64_tr_b16 v[90:91], v130 offset:9216
    s_waitcnt lgkmcnt(10)
    v_mfma_f32_16x16x32_bf16 v[56:59], v[76:79], v[96:99], 0
    ds_read_b64_tr_b16 v[92:93], v131 offset:8192
    ds_read_b64_tr_b16 v[94:95], v131 offset:9216
    s_mov_b64 exec, s[42:43]
    ds_read_b128 v[92:95], v132 offset:64
    s_mov_b64 exec, -1
    v_mfma_f32_16x16x32_bf16 v[60:63], v[76:79], v[100:103], 0
    s_waitcnt lgkmcnt(10)
    v_mfma_f32_16x16x32_bf16 v[8:11], v[80:83], v[112:115], v[8:11]
    s_waitcnt lgkmcnt(9)
    v_mfma_f32_16x16x32_bf16 v[12:15], v[80:83], v[116:119], v[12:15]
    s_waitcnt lgkmcnt(8)
    v_mfma_f32_16x16x32_bf16 v[16:19], v[80:83], v[120:123], v[16:19]
    s_waitcnt lgkmcnt(7)
    v_mfma_f32_16x16x32_bf16 v[20:23], v[80:83], v[124:127], v[20:23]
    s_waitcnt lgkmcnt(5)
    v_mfma_f32_16x16x32_bf16 v[24:27], v[84:87], v[112:115], v[24:27]
    s_waitcnt lgkmcnt(0)
    s_barrier
    v_mfma_f32_16x16x32_bf16 v[28:31], v[84:87], v[116:119], v[28:31]
    ds_read_b64_tr_b16 v[64:65], v128 offset:16384
    ds_read_b64_tr_b16 v[66:67], v128 offset:17408
    v_mfma_f32_16x16x32_bf16 v[32:35], v[84:87], v[120:123], v[32:35]
    ds_read_b128 v[96:99], v137 offset:0
    v_mfma_f32_16x16x32_bf16 v[36:39], v[84:87], v[124:127], v[36:39]
    ds_read_b128 v[100:103], v137 offset:2048
    v_mfma_f32_16x16x32_bf16 v[40:43], v[112:115], v[88:91], v[40:43]
    ds_read_b128 v[104:107], v139 offset:0
    v_mfma_f32_16x16x32_bf16 v[44:47], v[116:119], v[88:91], v[44:47]
    ds_read_b128 v[108:111], v139 offset:2048
    v_mfma_f32_16x16x32_bf16 v[48:51], v[120:123], v[88:91], v[48:51]
    ds_read_b64_tr_b16 v[68:69], v129 offset:16384
    ds_read_b64_tr_b16 v[70:71], v129 offset:17408
    v_mfma_f32_16x16x32_bf16 v[52:55], v[124:127], v[88:91], v[52:55]
    ds_read_b64_tr_b16 v[72:73], v130 offset:16384
    ds_read_b64_tr_b16 v[74:75], v130 offset:17408
    v_mfma_f32_16x16x32_bf16 v[56:59], v[92:95], v[112:115], v[56:59]
    ds_read_b64_tr_b16 v[76:77], v131 offset:16384
    ds_read_b64_tr_b16 v[78:79], v131 offset:17408
    s_mov_b64 exec, s[42:43]
    ds_read_b128 v[76:79], v132 offset:128
    s_mov_b64 exec, -1
    v_mfma_f32_16x16x32_bf16 v[60:63], v[92:95], v[116:119], v[60:63]
    s_waitcnt lgkmcnt(10)
    v_mfma_f32_16x16x32_bf16 v[8:11], v[64:67], v[96:99], v[8:11]
    s_waitcnt lgkmcnt(9)
    v_mfma_f32_16x16x32_bf16 v[12:15], v[64:67], v[100:103], v[12:15]
    s_waitcnt lgkmcnt(8)
    v_mfma_f32_16x16x32_bf16 v[16:19], v[64:67], v[104:107], v[16:19]
    s_waitcnt lgkmcnt(7)
    v_mfma_f32_16x16x32_bf16 v[20:23], v[64:67], v[108:111], v[20:23]
    s_waitcnt lgkmcnt(5)
    v_mfma_f32_16x16x32_bf16 v[24:27], v[68:71], v[96:99], v[24:27]
    v_mfma_f32_16x16x32_bf16 v[28:31], v[68:71], v[100:103], v[28:31]
    ds_read_b64_tr_b16 v[80:81], v128 offset:24576
    ds_read_b64_tr_b16 v[82:83], v128 offset:25600
    v_mfma_f32_16x16x32_bf16 v[32:35], v[68:71], v[104:107], v[32:35]
    ds_read_b128 v[112:115], v138 offset:0
    v_mfma_f32_16x16x32_bf16 v[36:39], v[68:71], v[108:111], v[36:39]
    ds_read_b128 v[116:119], v138 offset:2048
    s_waitcnt lgkmcnt(7)
    v_mfma_f32_16x16x32_bf16 v[40:43], v[96:99], v[72:75], v[40:43]
    ds_read_b128 v[120:123], v140 offset:0
    v_mfma_f32_16x16x32_bf16 v[44:47], v[100:103], v[72:75], v[44:47]
    ds_read_b128 v[124:127], v140 offset:2048
    v_mfma_f32_16x16x32_bf16 v[48:51], v[104:107], v[72:75], v[48:51]
    ds_read_b64_tr_b16 v[84:85], v129 offset:24576
    ds_read_b64_tr_b16 v[86:87], v129 offset:25600
    v_mfma_f32_16x16x32_bf16 v[52:55], v[108:111], v[72:75], v[52:55]
    ds_read_b64_tr_b16 v[88:89], v130 offset:24576
    ds_read_b64_tr_b16 v[90:91], v130 offset:25600
    s_waitcnt lgkmcnt(10)
    v_mfma_f32_16x16x32_bf16 v[56:59], v[76:79], v[96:99], v[56:59]
    ds_read_b64_tr_b16 v[92:93], v131 offset:24576
    ds_read_b64_tr_b16 v[94:95], v131 offset:25600
    s_mov_b64 exec, s[42:43]
    ds_read_b128 v[92:95], v132 offset:192
    s_mov_b64 exec, -1
    v_mfma_f32_16x16x32_bf16 v[60:63], v[76:79], v[100:103], v[60:63]
    s_waitcnt lgkmcnt(10)
    v_mfma_f32_16x16x32_bf16 v[8:11], v[80:83], v[112:115], v[8:11]
    s_waitcnt lgkmcnt(9)
    v_mfma_f32_16x16x32_bf16 v[12:15], v[80:83], v[116:119], v[12:15]
    s_waitcnt lgkmcnt(8)
    v_mfma_f32_16x16x32_bf16 v[16:19], v[80:83], v[120:123], v[16:19]
    s_waitcnt lgkmcnt(7)
    v_mfma_f32_16x16x32_bf16 v[20:23], v[80:83], v[124:127], v[20:23]
    s_waitcnt lgkmcnt(5)
    v_mfma_f32_16x16x32_bf16 v[24:27], v[84:87], v[112:115], v[24:27]
    s_waitcnt lgkmcnt(0)
    s_barrier
    v_mfma_f32_16x16x32_bf16 v[28:31], v[84:87], v[116:119], v[28:31]
    ds_read_b64_tr_b16 v[64:65], v128 offset:32768
    ds_read_b64_tr_b16 v[66:67], v128 offset:33792
    v_mfma_f32_16x16x32_bf16 v[32:35], v[84:87], v[120:123], v[32:35]
    ds_read_b128 v[96:99], v133 offset:0
    v_mfma_f32_16x16x32_bf16 v[36:39], v[84:87], v[124:127], v[36:39]
    ds_read_b128 v[100:103], v133 offset:2048
    v_mfma_f32_16x16x32_bf16 v[40:43], v[112:115], v[88:91], v[40:43]
    ds_read_b128 v[104:107], v135 offset:0
    v_mfma_f32_16x16x32_bf16 v[44:47], v[116:119], v[88:91], v[44:47]
    ds_read_b128 v[108:111], v135 offset:2048
    v_mfma_f32_16x16x32_bf16 v[48:51], v[120:123], v[88:91], v[48:51]
    ds_read_b64_tr_b16 v[68:69], v129 offset:32768
    ds_read_b64_tr_b16 v[70:71], v129 offset:33792
    v_mfma_f32_16x16x32_bf16 v[52:55], v[124:127], v[88:91], v[52:55]
    ds_read_b64_tr_b16 v[72:73], v130 offset:32768
    ds_read_b64_tr_b16 v[74:75], v130 offset:33792
    v_mfma_f32_16x16x32_bf16 v[56:59], v[92:95], v[112:115], v[56:59]
    ds_read_b64_tr_b16 v[76:77], v131 offset:32768
    ds_read_b64_tr_b16 v[78:79], v131 offset:33792
    s_mov_b64 exec, s[42:43]
    ds_read_b128 v[76:79], v132 offset:256
    s_mov_b64 exec, -1
    v_mfma_f32_16x16x32_bf16 v[60:63], v[92:95], v[116:119], v[60:63]
    s_waitcnt lgkmcnt(10)
    v_mfma_f32_16x16x32_bf16 v[8:11], v[64:67], v[96:99], v[8:11]
    s_waitcnt lgkmcnt(9)
    v_mfma_f32_16x16x32_bf16 v[12:15], v[64:67], v[100:103], v[12:15]
    s_waitcnt lgkmcnt(8)
    v_mfma_f32_16x16x32_bf16 v[16:19], v[64:67], v[104:107], v[16:19]
    s_waitcnt lgkmcnt(7)
    v_mfma_f32_16x16x32_bf16 v[20:23], v[64:67], v[108:111], v[20:23]
    s_waitcnt lgkmcnt(5)
    v_mfma_f32_16x16x32_bf16 v[24:27], v[68:71], v[96:99], v[24:27]
    v_mfma_f32_16x16x32_bf16 v[28:31], v[68:71], v[100:103], v[28:31]
    ds_read_b64_tr_b16 v[80:81], v128 offset:40960
    ds_read_b64_tr_b16 v[82:83], v128 offset:41984
    v_mfma_f32_16x16x32_bf16 v[32:35], v[68:71], v[104:107], v[32:35]
    ds_read_b128 v[112:115], v134 offset:0
    v_mfma_f32_16x16x32_bf16 v[36:39], v[68:71], v[108:111], v[36:39]
    ds_read_b128 v[116:119], v134 offset:2048
    s_waitcnt lgkmcnt(7)
    v_mfma_f32_16x16x32_bf16 v[40:43], v[96:99], v[72:75], v[40:43]
    ds_read_b128 v[120:123], v136 offset:0
    v_mfma_f32_16x16x32_bf16 v[44:47], v[100:103], v[72:75], v[44:47]
    ds_read_b128 v[124:127], v136 offset:2048
    v_mfma_f32_16x16x32_bf16 v[48:51], v[104:107], v[72:75], v[48:51]
    ds_read_b64_tr_b16 v[84:85], v129 offset:40960
    ds_read_b64_tr_b16 v[86:87], v129 offset:41984
    v_mfma_f32_16x16x32_bf16 v[52:55], v[108:111], v[72:75], v[52:55]
    ds_read_b64_tr_b16 v[88:89], v130 offset:40960
    ds_read_b64_tr_b16 v[90:91], v130 offset:41984
    s_waitcnt lgkmcnt(10)
    v_mfma_f32_16x16x32_bf16 v[56:59], v[76:79], v[96:99], v[56:59]
    ds_read_b64_tr_b16 v[92:93], v131 offset:40960
    ds_read_b64_tr_b16 v[94:95], v131 offset:41984
    s_mov_b64 exec, s[42:43]
    ds_read_b128 v[92:95], v132 offset:320
    s_mov_b64 exec, -1
    v_mfma_f32_16x16x32_bf16 v[60:63], v[76:79], v[100:103], v[60:63]
    s_waitcnt lgkmcnt(10)
    v_mfma_f32_16x16x32_bf16 v[8:11], v[80:83], v[112:115], v[8:11]
    s_waitcnt lgkmcnt(9)
    v_mfma_f32_16x16x32_bf16 v[12:15], v[80:83], v[116:119], v[12:15]
    s_waitcnt lgkmcnt(8)
    v_mfma_f32_16x16x32_bf16 v[16:19], v[80:83], v[120:123], v[16:19]
    s_waitcnt lgkmcnt(7)
    v_mfma_f32_16x16x32_bf16 v[20:23], v[80:83], v[124:127], v[20:23]
    s_waitcnt lgkmcnt(5)
    v_mfma_f32_16x16x32_bf16 v[24:27], v[84:87], v[112:115], v[24:27]
    s_waitcnt lgkmcnt(0)
    s_barrier
    v_mfma_f32_16x16x32_bf16 v[28:31], v[84:87], v[116:119], v[28:31]
    ds_read_b64_tr_b16 v[64:65], v128 offset:0
    ds_read_b64_tr_b16 v[66:67], v128 offset:1024
    v_mfma_f32_16x16x32_bf16 v[32:35], v[84:87], v[120:123], v[32:35]
    ds_read_b128 v[96:99], v133 offset:32768
    v_mfma_f32_16x16x32_bf16 v[36:39], v[84:87], v[124:127], v[36:39]
    ds_read_b128 v[100:103], v133 offset:34816
    v_mfma_f32_16x16x32_bf16 v[40:43], v[112:115], v[88:91], v[40:43]
    ds_read_b128 v[104:107], v135 offset:32768
    v_mfma_f32_16x16x32_bf16 v[44:47], v[116:119], v[88:91], v[44:47]
    ds_read_b128 v[108:111], v135 offset:34816
    v_mfma_f32_16x16x32_bf16 v[48:51], v[120:123], v[88:91], v[48:51]
    ds_read_b64_tr_b16 v[68:69], v129 offset:0
    ds_read_b64_tr_b16 v[70:71], v129 offset:1024
    v_mfma_f32_16x16x32_bf16 v[52:55], v[124:127], v[88:91], v[52:55]
    ds_read_b64_tr_b16 v[72:73], v130 offset:0
    ds_read_b64_tr_b16 v[74:75], v130 offset:1024
    v_mfma_f32_16x16x32_bf16 v[56:59], v[92:95], v[112:115], v[56:59]
    ds_read_b64_tr_b16 v[76:77], v131 offset:0
    ds_read_b64_tr_b16 v[78:79], v131 offset:1024
    s_mov_b64 exec, s[42:43]
    ds_read_b128 v[76:79], v132 offset:384
    s_mov_b64 exec, -1
    v_mfma_f32_16x16x32_bf16 v[60:63], v[92:95], v[116:119], v[60:63]
    s_waitcnt lgkmcnt(10)
    v_mfma_f32_16x16x32_bf16 v[8:11], v[64:67], v[96:99], v[8:11]
    s_waitcnt lgkmcnt(9)
    v_mfma_f32_16x16x32_bf16 v[12:15], v[64:67], v[100:103], v[12:15]
    s_waitcnt lgkmcnt(8)
    v_mfma_f32_16x16x32_bf16 v[16:19], v[64:67], v[104:107], v[16:19]
    s_waitcnt lgkmcnt(7)
    v_mfma_f32_16x16x32_bf16 v[20:23], v[64:67], v[108:111], v[20:23]
    s_waitcnt lgkmcnt(5)
    v_mfma_f32_16x16x32_bf16 v[24:27], v[68:71], v[96:99], v[24:27]
    v_mfma_f32_16x16x32_bf16 v[28:31], v[68:71], v[100:103], v[28:31]
    ds_read_b64_tr_b16 v[80:81], v128 offset:8192
    ds_read_b64_tr_b16 v[82:83], v128 offset:9216
    v_mfma_f32_16x16x32_bf16 v[32:35], v[68:71], v[104:107], v[32:35]
    ds_read_b128 v[112:115], v134 offset:32768
    v_mfma_f32_16x16x32_bf16 v[36:39], v[68:71], v[108:111], v[36:39]
    ds_read_b128 v[116:119], v134 offset:34816
    s_waitcnt lgkmcnt(7)
    v_mfma_f32_16x16x32_bf16 v[40:43], v[96:99], v[72:75], v[40:43]
    ds_read_b128 v[120:123], v136 offset:32768
    v_mfma_f32_16x16x32_bf16 v[44:47], v[100:103], v[72:75], v[44:47]
    ds_read_b128 v[124:127], v136 offset:34816
    v_mfma_f32_16x16x32_bf16 v[48:51], v[104:107], v[72:75], v[48:51]
    ds_read_b64_tr_b16 v[84:85], v129 offset:8192
    ds_read_b64_tr_b16 v[86:87], v129 offset:9216
    v_mfma_f32_16x16x32_bf16 v[52:55], v[108:111], v[72:75], v[52:55]
    ds_read_b64_tr_b16 v[88:89], v130 offset:8192
    ds_read_b64_tr_b16 v[90:91], v130 offset:9216
    s_waitcnt lgkmcnt(10)
    v_mfma_f32_16x16x32_bf16 v[56:59], v[76:79], v[96:99], v[56:59]
    ds_read_b64_tr_b16 v[92:93], v131 offset:8192
    ds_read_b64_tr_b16 v[94:95], v131 offset:9216
    s_mov_b64 exec, s[42:43]
    ds_read_b128 v[92:95], v132 offset:448
    s_mov_b64 exec, -1
    v_mfma_f32_16x16x32_bf16 v[60:63], v[76:79], v[100:103], v[60:63]
    s_waitcnt lgkmcnt(10)
    v_mfma_f32_16x16x32_bf16 v[8:11], v[80:83], v[112:115], v[8:11]
    s_waitcnt lgkmcnt(9)
    v_mfma_f32_16x16x32_bf16 v[12:15], v[80:83], v[116:119], v[12:15]
    s_waitcnt lgkmcnt(8)
    v_mfma_f32_16x16x32_bf16 v[16:19], v[80:83], v[120:123], v[16:19]
    s_waitcnt lgkmcnt(7)
    v_mfma_f32_16x16x32_bf16 v[20:23], v[80:83], v[124:127], v[20:23]
    s_waitcnt lgkmcnt(5)
    v_mfma_f32_16x16x32_bf16 v[24:27], v[84:87], v[112:115], v[24:27]
    s_waitcnt lgkmcnt(0)
    s_barrier
    v_mfma_f32_16x16x32_bf16 v[28:31], v[84:87], v[116:119], v[28:31]
    ds_read_b64_tr_b16 v[64:65], v128 offset:16384
    ds_read_b64_tr_b16 v[66:67], v128 offset:17408
    v_mfma_f32_16x16x32_bf16 v[32:35], v[84:87], v[120:123], v[32:35]
    ds_read_b128 v[96:99], v137 offset:0
    v_mfma_f32_16x16x32_bf16 v[36:39], v[84:87], v[124:127], v[36:39]
    ds_read_b128 v[100:103], v137 offset:2048
    v_mfma_f32_16x16x32_bf16 v[40:43], v[112:115], v[88:91], v[40:43]
    ds_read_b128 v[104:107], v139 offset:0
    v_mfma_f32_16x16x32_bf16 v[44:47], v[116:119], v[88:91], v[44:47]
    ds_read_b128 v[108:111], v139 offset:2048
    v_mfma_f32_16x16x32_bf16 v[48:51], v[120:123], v[88:91], v[48:51]
    ds_read_b64_tr_b16 v[68:69], v129 offset:16384
    ds_read_b64_tr_b16 v[70:71], v129 offset:17408
    v_mfma_f32_16x16x32_bf16 v[52:55], v[124:127], v[88:91], v[52:55]
    ds_read_b64_tr_b16 v[72:73], v130 offset:16384
    ds_read_b64_tr_b16 v[74:75], v130 offset:17408
    v_mfma_f32_16x16x32_bf16 v[56:59], v[92:95], v[112:115], v[56:59]
    ds_read_b64_tr_b16 v[76:77], v131 offset:16384
    ds_read_b64_tr_b16 v[78:79], v131 offset:17408
    s_mov_b64 exec, s[42:43]
    ds_read_b128 v[76:79], v132 offset:512
    s_mov_b64 exec, -1
    v_mfma_f32_16x16x32_bf16 v[60:63], v[92:95], v[116:119], v[60:63]
    s_waitcnt lgkmcnt(10)
    v_mfma_f32_16x16x32_bf16 v[8:11], v[64:67], v[96:99], v[8:11]
    s_waitcnt lgkmcnt(9)
    v_mfma_f32_16x16x32_bf16 v[12:15], v[64:67], v[100:103], v[12:15]
    s_waitcnt lgkmcnt(8)
    v_mfma_f32_16x16x32_bf16 v[16:19], v[64:67], v[104:107], v[16:19]
    s_waitcnt lgkmcnt(7)
    v_mfma_f32_16x16x32_bf16 v[20:23], v[64:67], v[108:111], v[20:23]
    s_waitcnt lgkmcnt(5)
    v_mfma_f32_16x16x32_bf16 v[24:27], v[68:71], v[96:99], v[24:27]
    v_mfma_f32_16x16x32_bf16 v[28:31], v[68:71], v[100:103], v[28:31]
    ds_read_b64_tr_b16 v[80:81], v128 offset:24576
    ds_read_b64_tr_b16 v[82:83], v128 offset:25600
    v_mfma_f32_16x16x32_bf16 v[32:35], v[68:71], v[104:107], v[32:35]
    ds_read_b128 v[112:115], v138 offset:0
    v_mfma_f32_16x16x32_bf16 v[36:39], v[68:71], v[108:111], v[36:39]
    ds_read_b128 v[116:119], v138 offset:2048
    s_waitcnt lgkmcnt(7)
    v_mfma_f32_16x16x32_bf16 v[40:43], v[96:99], v[72:75], v[40:43]
    ds_read_b128 v[120:123], v140 offset:0
    v_mfma_f32_16x16x32_bf16 v[44:47], v[100:103], v[72:75], v[44:47]
    ds_read_b128 v[124:127], v140 offset:2048
    v_mfma_f32_16x16x32_bf16 v[48:51], v[104:107], v[72:75], v[48:51]
    ds_read_b64_tr_b16 v[84:85], v129 offset:24576
    ds_read_b64_tr_b16 v[86:87], v129 offset:25600
    v_mfma_f32_16x16x32_bf16 v[52:55], v[108:111], v[72:75], v[52:55]
    ds_read_b64_tr_b16 v[88:89], v130 offset:24576
    ds_read_b64_tr_b16 v[90:91], v130 offset:25600
    s_waitcnt lgkmcnt(10)
    v_mfma_f32_16x16x32_bf16 v[56:59], v[76:79], v[96:99], v[56:59]
    ds_read_b64_tr_b16 v[92:93], v131 offset:24576
    ds_read_b64_tr_b16 v[94:95], v131 offset:25600
    s_mov_b64 exec, s[42:43]
    ds_read_b128 v[92:95], v132 offset:576
    s_mov_b64 exec, -1
    v_mfma_f32_16x16x32_bf16 v[60:63], v[76:79], v[100:103], v[60:63]
    s_waitcnt lgkmcnt(10)
    v_mfma_f32_16x16x32_bf16 v[8:11], v[80:83], v[112:115], v[8:11]
    s_waitcnt lgkmcnt(9)
    v_mfma_f32_16x16x32_bf16 v[12:15], v[80:83], v[116:119], v[12:15]
    s_waitcnt lgkmcnt(8)
    v_mfma_f32_16x16x32_bf16 v[16:19], v[80:83], v[120:123], v[16:19]
    s_waitcnt lgkmcnt(7)
    v_mfma_f32_16x16x32_bf16 v[20:23], v[80:83], v[124:127], v[20:23]
    s_waitcnt lgkmcnt(5)
    v_mfma_f32_16x16x32_bf16 v[24:27], v[84:87], v[112:115], v[24:27]
    s_waitcnt lgkmcnt(0)
    s_barrier
    v_mfma_f32_16x16x32_bf16 v[28:31], v[84:87], v[116:119], v[28:31]
    ds_read_b64_tr_b16 v[64:65], v128 offset:32768
    ds_read_b64_tr_b16 v[66:67], v128 offset:33792
    v_mfma_f32_16x16x32_bf16 v[32:35], v[84:87], v[120:123], v[32:35]
    ds_read_b128 v[96:99], v133 offset:0
    v_mfma_f32_16x16x32_bf16 v[36:39], v[84:87], v[124:127], v[36:39]
    ds_read_b128 v[100:103], v133 offset:2048
    v_mfma_f32_16x16x32_bf16 v[40:43], v[112:115], v[88:91], v[40:43]
    ds_read_b128 v[104:107], v135 offset:0
    v_mfma_f32_16x16x32_bf16 v[44:47], v[116:119], v[88:91], v[44:47]
    ds_read_b128 v[108:111], v135 offset:2048
    v_mfma_f32_16x16x32_bf16 v[48:51], v[120:123], v[88:91], v[48:51]
    ds_read_b64_tr_b16 v[68:69], v129 offset:32768
    ds_read_b64_tr_b16 v[70:71], v129 offset:33792
    v_mfma_f32_16x16x32_bf16 v[52:55], v[124:127], v[88:91], v[52:55]
    ds_read_b64_tr_b16 v[72:73], v130 offset:32768
    ds_read_b64_tr_b16 v[74:75], v130 offset:33792
    v_mfma_f32_16x16x32_bf16 v[56:59], v[92:95], v[112:115], v[56:59]
    ds_read_b64_tr_b16 v[76:77], v131 offset:32768
    ds_read_b64_tr_b16 v[78:79], v131 offset:33792
    s_mov_b64 exec, s[42:43]
    ds_read_b128 v[76:79], v132 offset:640
    s_mov_b64 exec, -1
    v_mfma_f32_16x16x32_bf16 v[60:63], v[92:95], v[116:119], v[60:63]
    s_waitcnt lgkmcnt(10)
    v_mfma_f32_16x16x32_bf16 v[8:11], v[64:67], v[96:99], v[8:11]
    s_waitcnt lgkmcnt(9)
    v_mfma_f32_16x16x32_bf16 v[12:15], v[64:67], v[100:103], v[12:15]
    s_waitcnt lgkmcnt(8)
    v_mfma_f32_16x16x32_bf16 v[16:19], v[64:67], v[104:107], v[16:19]
    s_waitcnt lgkmcnt(7)
    v_mfma_f32_16x16x32_bf16 v[20:23], v[64:67], v[108:111], v[20:23]
    s_waitcnt lgkmcnt(5)
    v_mfma_f32_16x16x32_bf16 v[24:27], v[68:71], v[96:99], v[24:27]
    v_mfma_f32_16x16x32_bf16 v[28:31], v[68:71], v[100:103], v[28:31]
    ds_read_b64_tr_b16 v[80:81], v128 offset:40960
    ds_read_b64_tr_b16 v[82:83], v128 offset:41984
    v_mfma_f32_16x16x32_bf16 v[32:35], v[68:71], v[104:107], v[32:35]
    ds_read_b128 v[112:115], v134 offset:0
    v_mfma_f32_16x16x32_bf16 v[36:39], v[68:71], v[108:111], v[36:39]
    ds_read_b128 v[116:119], v134 offset:2048
    s_waitcnt lgkmcnt(7)
    v_mfma_f32_16x16x32_bf16 v[40:43], v[96:99], v[72:75], v[40:43]
    ds_read_b128 v[120:123], v136 offset:0
    v_mfma_f32_16x16x32_bf16 v[44:47], v[100:103], v[72:75], v[44:47]
    ds_read_b128 v[124:127], v136 offset:2048
    v_mfma_f32_16x16x32_bf16 v[48:51], v[104:107], v[72:75], v[48:51]
    ds_read_b64_tr_b16 v[84:85], v129 offset:40960
    ds_read_b64_tr_b16 v[86:87], v129 offset:41984
    v_mfma_f32_16x16x32_bf16 v[52:55], v[108:111], v[72:75], v[52:55]
    ds_read_b64_tr_b16 v[88:89], v130 offset:40960
    ds_read_b64_tr_b16 v[90:91], v130 offset:41984
    s_waitcnt lgkmcnt(10)
    v_mfma_f32_16x16x32_bf16 v[56:59], v[76:79], v[96:99], v[56:59]
    ds_read_b64_tr_b16 v[92:93], v131 offset:40960
    ds_read_b64_tr_b16 v[94:95], v131 offset:41984
    s_mov_b64 exec, s[42:43]
    ds_read_b128 v[92:95], v132 offset:704
    s_mov_b64 exec, -1
    v_mfma_f32_16x16x32_bf16 v[60:63], v[76:79], v[100:103], v[60:63]
    s_waitcnt lgkmcnt(10)
    v_mfma_f32_16x16x32_bf16 v[8:11], v[80:83], v[112:115], v[8:11]
    s_waitcnt lgkmcnt(9)
    v_mfma_f32_16x16x32_bf16 v[12:15], v[80:83], v[116:119], v[12:15]
    s_waitcnt lgkmcnt(8)
    v_mfma_f32_16x16x32_bf16 v[16:19], v[80:83], v[120:123], v[16:19]
    s_waitcnt lgkmcnt(7)
    v_mfma_f32_16x16x32_bf16 v[20:23], v[80:83], v[124:127], v[20:23]
    s_waitcnt lgkmcnt(5)
    v_mfma_f32_16x16x32_bf16 v[24:27], v[84:87], v[112:115], v[24:27]
    s_waitcnt lgkmcnt(0)
    s_barrier
    v_mfma_f32_16x16x32_bf16 v[28:31], v[84:87], v[116:119], v[28:31]
    ds_read_b64_tr_b16 v[64:65], v128 offset:0
    ds_read_b64_tr_b16 v[66:67], v128 offset:1024
    v_mfma_f32_16x16x32_bf16 v[32:35], v[84:87], v[120:123], v[32:35]
    ds_read_b128 v[96:99], v133 offset:32768
    v_mfma_f32_16x16x32_bf16 v[36:39], v[84:87], v[124:127], v[36:39]
    ds_read_b128 v[100:103], v133 offset:34816
    v_mfma_f32_16x16x32_bf16 v[40:43], v[112:115], v[88:91], v[40:43]
    ds_read_b128 v[104:107], v135 offset:32768
    v_mfma_f32_16x16x32_bf16 v[44:47], v[116:119], v[88:91], v[44:47]
    ds_read_b128 v[108:111], v135 offset:34816
    v_mfma_f32_16x16x32_bf16 v[48:51], v[120:123], v[88:91], v[48:51]
    ds_read_b64_tr_b16 v[68:69], v129 offset:0
    ds_read_b64_tr_b16 v[70:71], v129 offset:1024
    v_mfma_f32_16x16x32_bf16 v[52:55], v[124:127], v[88:91], v[52:55]
    ds_read_b64_tr_b16 v[72:73], v130 offset:0
    ds_read_b64_tr_b16 v[74:75], v130 offset:1024
    v_mfma_f32_16x16x32_bf16 v[56:59], v[92:95], v[112:115], v[56:59]
    ds_read_b64_tr_b16 v[76:77], v131 offset:0
    ds_read_b64_tr_b16 v[78:79], v131 offset:1024
    s_mov_b64 exec, s[42:43]
    ds_read_b128 v[76:79], v132 offset:768
    s_mov_b64 exec, -1
    v_mfma_f32_16x16x32_bf16 v[60:63], v[92:95], v[116:119], v[60:63]
    s_waitcnt lgkmcnt(10)
    v_mfma_f32_16x16x32_bf16 v[8:11], v[64:67], v[96:99], v[8:11]
    s_waitcnt lgkmcnt(9)
    v_mfma_f32_16x16x32_bf16 v[12:15], v[64:67], v[100:103], v[12:15]
    s_waitcnt lgkmcnt(8)
    v_mfma_f32_16x16x32_bf16 v[16:19], v[64:67], v[104:107], v[16:19]
    s_waitcnt lgkmcnt(7)
    v_mfma_f32_16x16x32_bf16 v[20:23], v[64:67], v[108:111], v[20:23]
    s_waitcnt lgkmcnt(5)
    v_mfma_f32_16x16x32_bf16 v[24:27], v[68:71], v[96:99], v[24:27]
    v_mfma_f32_16x16x32_bf16 v[28:31], v[68:71], v[100:103], v[28:31]
    ds_read_b64_tr_b16 v[80:81], v128 offset:8192
    ds_read_b64_tr_b16 v[82:83], v128 offset:9216
    v_mfma_f32_16x16x32_bf16 v[32:35], v[68:71], v[104:107], v[32:35]
    ds_read_b128 v[112:115], v134 offset:32768
    v_mfma_f32_16x16x32_bf16 v[36:39], v[68:71], v[108:111], v[36:39]
    ds_read_b128 v[116:119], v134 offset:34816
    s_waitcnt lgkmcnt(7)
    v_mfma_f32_16x16x32_bf16 v[40:43], v[96:99], v[72:75], v[40:43]
    ds_read_b128 v[120:123], v136 offset:32768
    v_mfma_f32_16x16x32_bf16 v[44:47], v[100:103], v[72:75], v[44:47]
    ds_read_b128 v[124:127], v136 offset:34816
    v_mfma_f32_16x16x32_bf16 v[48:51], v[104:107], v[72:75], v[48:51]
    ds_read_b64_tr_b16 v[84:85], v129 offset:8192
    ds_read_b64_tr_b16 v[86:87], v129 offset:9216
    v_mfma_f32_16x16x32_bf16 v[52:55], v[108:111], v[72:75], v[52:55]
    ds_read_b64_tr_b16 v[88:89], v130 offset:8192
    ds_read_b64_tr_b16 v[90:91], v130 offset:9216
    s_waitcnt lgkmcnt(10)
    v_mfma_f32_16x16x32_bf16 v[56:59], v[76:79], v[96:99], v[56:59]
    ds_read_b64_tr_b16 v[92:93], v131 offset:8192
    ds_read_b64_tr_b16 v[94:95], v131 offset:9216
    s_mov_b64 exec, s[42:43]
    ds_read_b128 v[92:95], v132 offset:832
    s_mov_b64 exec, -1
    v_mfma_f32_16x16x32_bf16 v[60:63], v[76:79], v[100:103], v[60:63]
    s_waitcnt lgkmcnt(10)
    v_mfma_f32_16x16x32_bf16 v[8:11], v[80:83], v[112:115], v[8:11]
    s_waitcnt lgkmcnt(9)
    v_mfma_f32_16x16x32_bf16 v[12:15], v[80:83], v[116:119], v[12:15]
    s_waitcnt lgkmcnt(8)
    v_mfma_f32_16x16x32_bf16 v[16:19], v[80:83], v[120:123], v[16:19]
    s_waitcnt lgkmcnt(7)
    v_mfma_f32_16x16x32_bf16 v[20:23], v[80:83], v[124:127], v[20:23]
    s_waitcnt lgkmcnt(5)
    v_mfma_f32_16x16x32_bf16 v[24:27], v[84:87], v[112:115], v[24:27]
    s_waitcnt lgkmcnt(0)
    s_barrier
    v_mfma_f32_16x16x32_bf16 v[28:31], v[84:87], v[116:119], v[28:31]
    ds_read_b64_tr_b16 v[64:65], v128 offset:16384
    ds_read_b64_tr_b16 v[66:67], v128 offset:17408
    v_mfma_f32_16x16x32_bf16 v[32:35], v[84:87], v[120:123], v[32:35]
    ds_read_b128 v[96:99], v137 offset:0
    v_mfma_f32_16x16x32_bf16 v[36:39], v[84:87], v[124:127], v[36:39]
    ds_read_b128 v[100:103], v137 offset:2048
    v_mfma_f32_16x16x32_bf16 v[40:43], v[112:115], v[88:91], v[40:43]
    ds_read_b128 v[104:107], v139 offset:0
    v_mfma_f32_16x16x32_bf16 v[44:47], v[116:119], v[88:91], v[44:47]
    ds_read_b128 v[108:111], v139 offset:2048
    v_mfma_f32_16x16x32_bf16 v[48:51], v[120:123], v[88:91], v[48:51]
    ds_read_b64_tr_b16 v[68:69], v129 offset:16384
    ds_read_b64_tr_b16 v[70:71], v129 offset:17408
    v_mfma_f32_16x16x32_bf16 v[52:55], v[124:127], v[88:91], v[52:55]
    ds_read_b64_tr_b16 v[72:73], v130 offset:16384
    ds_read_b64_tr_b16 v[74:75], v130 offset:17408
    v_mfma_f32_16x16x32_bf16 v[56:59], v[92:95], v[112:115], v[56:59]
    ds_read_b64_tr_b16 v[76:77], v131 offset:16384
    ds_read_b64_tr_b16 v[78:79], v131 offset:17408
    s_mov_b64 exec, s[42:43]
    ds_read_b128 v[76:79], v132 offset:896
    s_mov_b64 exec, -1
    v_mfma_f32_16x16x32_bf16 v[60:63], v[92:95], v[116:119], v[60:63]
    s_waitcnt lgkmcnt(10)
    v_mfma_f32_16x16x32_bf16 v[8:11], v[64:67], v[96:99], v[8:11]
    s_waitcnt lgkmcnt(9)
    v_mfma_f32_16x16x32_bf16 v[12:15], v[64:67], v[100:103], v[12:15]
    s_waitcnt lgkmcnt(8)
    v_mfma_f32_16x16x32_bf16 v[16:19], v[64:67], v[104:107], v[16:19]
    s_waitcnt lgkmcnt(7)
    v_mfma_f32_16x16x32_bf16 v[20:23], v[64:67], v[108:111], v[20:23]
    s_waitcnt lgkmcnt(5)
    v_mfma_f32_16x16x32_bf16 v[24:27], v[68:71], v[96:99], v[24:27]
    v_mfma_f32_16x16x32_bf16 v[28:31], v[68:71], v[100:103], v[28:31]
    ds_read_b64_tr_b16 v[80:81], v128 offset:24576
    ds_read_b64_tr_b16 v[82:83], v128 offset:25600
    v_mfma_f32_16x16x32_bf16 v[32:35], v[68:71], v[104:107], v[32:35]
    ds_read_b128 v[112:115], v138 offset:0
    v_mfma_f32_16x16x32_bf16 v[36:39], v[68:71], v[108:111], v[36:39]
    ds_read_b128 v[116:119], v138 offset:2048
    s_waitcnt lgkmcnt(7)
    v_mfma_f32_16x16x32_bf16 v[40:43], v[96:99], v[72:75], v[40:43]
    ds_read_b128 v[120:123], v140 offset:0
    v_mfma_f32_16x16x32_bf16 v[44:47], v[100:103], v[72:75], v[44:47]
    ds_read_b128 v[124:127], v140 offset:2048
    v_mfma_f32_16x16x32_bf16 v[48:51], v[104:107], v[72:75], v[48:51]
    ds_read_b64_tr_b16 v[84:85], v129 offset:24576
    ds_read_b64_tr_b16 v[86:87], v129 offset:25600
    v_mfma_f32_16x16x32_bf16 v[52:55], v[108:111], v[72:75], v[52:55]
    ds_read_b64_tr_b16 v[88:89], v130 offset:24576
    ds_read_b64_tr_b16 v[90:91], v130 offset:25600
    s_waitcnt lgkmcnt(10)
    v_mfma_f32_16x16x32_bf16 v[56:59], v[76:79], v[96:99], v[56:59]
    ds_read_b64_tr_b16 v[92:93], v131 offset:24576
    ds_read_b64_tr_b16 v[94:95], v131 offset:25600
    s_mov_b64 exec, s[42:43]
    ds_read_b128 v[92:95], v132 offset:960
    s_mov_b64 exec, -1
    v_mfma_f32_16x16x32_bf16 v[60:63], v[76:79], v[100:103], v[60:63]
    s_waitcnt lgkmcnt(10)
    v_mfma_f32_16x16x32_bf16 v[8:11], v[80:83], v[112:115], v[8:11]
    s_waitcnt lgkmcnt(9)
    v_mfma_f32_16x16x32_bf16 v[12:15], v[80:83], v[116:119], v[12:15]
    s_waitcnt lgkmcnt(8)
    v_mfma_f32_16x16x32_bf16 v[16:19], v[80:83], v[120:123], v[16:19]
    s_waitcnt lgkmcnt(7)
    v_mfma_f32_16x16x32_bf16 v[20:23], v[80:83], v[124:127], v[20:23]
    s_waitcnt lgkmcnt(5)
    v_mfma_f32_16x16x32_bf16 v[24:27], v[84:87], v[112:115], v[24:27]
    s_waitcnt lgkmcnt(0)
    s_barrier
    v_mfma_f32_16x16x32_bf16 v[28:31], v[84:87], v[116:119], v[28:31]
    ds_read_b64_tr_b16 v[64:65], v128 offset:32768
    ds_read_b64_tr_b16 v[66:67], v128 offset:33792
    v_mfma_f32_16x16x32_bf16 v[32:35], v[84:87], v[120:123], v[32:35]
    ds_read_b128 v[96:99], v133 offset:0
    v_mfma_f32_16x16x32_bf16 v[36:39], v[84:87], v[124:127], v[36:39]
    ds_read_b128 v[100:103], v133 offset:2048
    v_mfma_f32_16x16x32_bf16 v[40:43], v[112:115], v[88:91], v[40:43]
    ds_read_b128 v[104:107], v135 offset:0
    v_mfma_f32_16x16x32_bf16 v[44:47], v[116:119], v[88:91], v[44:47]
    ds_read_b128 v[108:111], v135 offset:2048
    v_mfma_f32_16x16x32_bf16 v[48:51], v[120:123], v[88:91], v[48:51]
    ds_read_b64_tr_b16 v[68:69], v129 offset:32768
    ds_read_b64_tr_b16 v[70:71], v129 offset:33792
    v_mfma_f32_16x16x32_bf16 v[52:55], v[124:127], v[88:91], v[52:55]
    ds_read_b64_tr_b16 v[72:73], v130 offset:32768
    ds_read_b64_tr_b16 v[74:75], v130 offset:33792
    v_mfma_f32_16x16x32_bf16 v[56:59], v[92:95], v[112:115], v[56:59]
    ds_read_b64_tr_b16 v[76:77], v131 offset:32768
    ds_read_b64_tr_b16 v[78:79], v131 offset:33792
    s_mov_b64 exec, s[42:43]
    ds_read_b128 v[76:79], v132 offset:1024
    s_mov_b64 exec, -1
    v_mfma_f32_16x16x32_bf16 v[60:63], v[92:95], v[116:119], v[60:63]
    s_waitcnt lgkmcnt(10)
    v_mfma_f32_16x16x32_bf16 v[8:11], v[64:67], v[96:99], v[8:11]
    s_waitcnt lgkmcnt(9)
    v_mfma_f32_16x16x32_bf16 v[12:15], v[64:67], v[100:103], v[12:15]
    s_waitcnt lgkmcnt(8)
    v_mfma_f32_16x16x32_bf16 v[16:19], v[64:67], v[104:107], v[16:19]
    s_waitcnt lgkmcnt(7)
    v_mfma_f32_16x16x32_bf16 v[20:23], v[64:67], v[108:111], v[20:23]
    s_waitcnt lgkmcnt(5)
    v_mfma_f32_16x16x32_bf16 v[24:27], v[68:71], v[96:99], v[24:27]
    s_waitcnt lgkmcnt(0)
    s_barrier
    v_mfma_f32_16x16x32_bf16 v[28:31], v[68:71], v[100:103], v[28:31]
    ds_read_b64_tr_b16 v[80:81], v128 offset:40960
    ds_read_b64_tr_b16 v[82:83], v128 offset:41984
    v_mfma_f32_16x16x32_bf16 v[32:35], v[68:71], v[104:107], v[32:35]
    ds_read_b128 v[112:115], v134 offset:0
    v_mfma_f32_16x16x32_bf16 v[36:39], v[68:71], v[108:111], v[36:39]
    ds_read_b128 v[116:119], v134 offset:2048
    v_mfma_f32_16x16x32_bf16 v[40:43], v[96:99], v[72:75], v[40:43]
    ds_read_b128 v[120:123], v136 offset:0
    v_mfma_f32_16x16x32_bf16 v[44:47], v[100:103], v[72:75], v[44:47]
    ds_read_b128 v[124:127], v136 offset:2048
    v_mfma_f32_16x16x32_bf16 v[48:51], v[104:107], v[72:75], v[48:51]
    ds_read_b64_tr_b16 v[84:85], v129 offset:40960
    ds_read_b64_tr_b16 v[86:87], v129 offset:41984
    v_mfma_f32_16x16x32_bf16 v[52:55], v[108:111], v[72:75], v[52:55]
    ds_read_b64_tr_b16 v[88:89], v130 offset:40960
    ds_read_b64_tr_b16 v[90:91], v130 offset:41984
    v_mfma_f32_16x16x32_bf16 v[56:59], v[76:79], v[96:99], v[56:59]
    ds_read_b64_tr_b16 v[92:93], v131 offset:40960
    ds_read_b64_tr_b16 v[94:95], v131 offset:41984
    s_mov_b64 exec, s[42:43]
    ds_read_b128 v[92:95], v132 offset:1088
    s_mov_b64 exec, -1
    v_mfma_f32_16x16x32_bf16 v[60:63], v[76:79], v[100:103], v[60:63]
    s_waitcnt lgkmcnt(10)
    v_mfma_f32_16x16x32_bf16 v[8:11], v[80:83], v[112:115], v[8:11]
    s_waitcnt lgkmcnt(9)
    v_mfma_f32_16x16x32_bf16 v[12:15], v[80:83], v[116:119], v[12:15]
    s_waitcnt lgkmcnt(8)
    v_mfma_f32_16x16x32_bf16 v[16:19], v[80:83], v[120:123], v[16:19]
    s_waitcnt lgkmcnt(7)
    v_mfma_f32_16x16x32_bf16 v[20:23], v[80:83], v[124:127], v[20:23]
    s_waitcnt lgkmcnt(5)
    v_mfma_f32_16x16x32_bf16 v[24:27], v[84:87], v[112:115], v[24:27]
    v_mfma_f32_16x16x32_bf16 v[28:31], v[84:87], v[116:119], v[28:31]
    v_mfma_f32_16x16x32_bf16 v[32:35], v[84:87], v[120:123], v[32:35]
    v_mfma_f32_16x16x32_bf16 v[36:39], v[84:87], v[124:127], v[36:39]
    s_waitcnt lgkmcnt(3)
    v_mfma_f32_16x16x32_bf16 v[40:43], v[112:115], v[88:91], v[40:43]
    v_mfma_f32_16x16x32_bf16 v[44:47], v[116:119], v[88:91], v[44:47]
    v_mfma_f32_16x16x32_bf16 v[48:51], v[120:123], v[88:91], v[48:51]
    v_mfma_f32_16x16x32_bf16 v[52:55], v[124:127], v[88:91], v[52:55]
    s_waitcnt lgkmcnt(0)
    v_mfma_f32_16x16x32_bf16 v[56:59], v[92:95], v[112:115], v[56:59]
    v_mfma_f32_16x16x32_bf16 v[60:63], v[92:95], v[116:119], v[60:63]
    s_waitcnt vmcnt(0)
    v_mul_f32 v8, s36, v8
    v_mul_f32 v9, s36, v9
    v_mul_f32 v10, s36, v10
    v_mul_f32 v11, s36, v11
    v_mul_f32 v12, s36, v12
    v_mul_f32 v13, s36, v13
    v_mul_f32 v14, s36, v14
    v_mul_f32 v15, s36, v15
    v_mul_f32 v16, s36, v16
    v_mul_f32 v17, s36, v17
    v_mul_f32 v18, s36, v18
    v_mul_f32 v19, s36, v19
    v_mul_f32 v20, s36, v20
    v_mul_f32 v21, s36, v21
    v_mul_f32 v22, s36, v22
    v_mul_f32 v23, s36, v23
    v_cvt_pk_bf16_f32 v64, v24, v25
    v_cvt_pk_bf16_f32 v65, v26, v27
    v_cvt_pk_bf16_f32 v66, v28, v29
    v_cvt_pk_bf16_f32 v67, v30, v31
    v_cvt_pk_bf16_f32 v68, v32, v33
    v_cvt_pk_bf16_f32 v69, v34, v35
    v_cvt_pk_bf16_f32 v70, v36, v37
    v_cvt_pk_bf16_f32 v71, v38, v39
    v_permlane16_swap_b32 v64, v66
    v_permlane16_swap_b32 v65, v67
    v_cvt_pk_bf16_f32 v104, v8, v9
    v_cvt_pk_bf16_f32 v105, v10, v11
    v_cvt_pk_bf16_f32 v106, v12, v13
    v_cvt_pk_bf16_f32 v107, v14, v15
    v_permlane16_swap_b32 v68, v70
    v_permlane16_swap_b32 v69, v71
    ds_write_b128 v141, v[64:67]
    ds_write_b128 v142, v[68:71]
    v_cvt_pk_bf16_f32 v108, v16, v17
    v_cvt_pk_bf16_f32 v109, v18, v19
    v_cvt_pk_bf16_f32 v110, v20, v21
    v_cvt_pk_bf16_f32 v111, v22, v23
    v_permlane16_swap_b32 v104, v106
    v_permlane16_swap_b32 v105, v107
    v_bfe_u32 v84, v1, 3, 1
    s_mov_b32 s29, 0x3f803f80
    v_permlane16_swap_b32 v108, v110
    v_permlane16_swap_b32 v109, v111
    v_mul_lo_u32 v84, v84, s29
    v_mov_b32 v88, 0x3f80
    v_mfma_f32_32x32x16_bf16 v[8:23], v[64:67], v[104:107], 0
    v_mfma_f32_32x32x16_bf16 v[24:39], v[64:67], v[108:111], 0
    v_cvt_pk_bf16_f32 v72, v40, v41
    v_cvt_pk_bf16_f32 v73, v42, v43
    ds_write_b64 v143, v[72:73] offset:0
    v_cvt_pk_bf16_f32 v74, v44, v45
    v_cvt_pk_bf16_f32 v75, v46, v47
    ds_write_b64 v143, v[74:75] offset:640
    v_cvt_pk_bf16_f32 v76, v48, v49
    v_cvt_pk_bf16_f32 v77, v50, v51
    ds_write_b64 v144, v[76:77] offset:0
    v_cvt_pk_bf16_f32 v78, v52, v53
    v_cvt_pk_bf16_f32 v79, v54, v55
    ds_write_b64 v144, v[78:79] offset:640
    v_mov_b32 v85, v84
    v_mov_b32 v86, v84
    v_mov_b32 v87, v84
    ds_write_b32 v147, v88
    s_mov_b64 exec, 0xffff
    ds_write_b128 v146, v[84:87]
    s_mov_b64 exec, -1
    v_mul_f32 v56, v148, v56
    v_mul_f32 v57, v148, v57
    v_mul_f32 v58, v148, v58
    v_mul_f32 v59, v148, v59
    v_cvt_pk_bf16_f32 v80, v56, v57
    v_cvt_pk_bf16_f32 v81, v58, v59
    s_mov_b32 exec_lo, 0
    s_mov_b32 exec_hi, 0xffff
    ds_write_b16 v145, v80 offset:144
    ds_write_b16_d16_hi v145, v80 offset:160
    ds_write_b16 v145, v81 offset:20624
    ds_write_b16_d16_hi v145, v81 offset:20640
    s_mov_b32 exec_hi, 0xffff0000
    v_mov_b32 v80, v56
    v_mov_b32 v81, v56
    s_mov_b32 exec_lo, -1
    ds_write_b32 v145, v80 offset:0
    ds_write_b32 v145, v81 offset:20480
    s_mov_b64 exec, -1
    v_mul_f32 v60, v148, v60
    v_mul_f32 v61, v148, v61
    v_mul_f32 v62, v148, v62
    v_mul_f32 v63, v148, v63
    v_cvt_pk_bf16_f32 v82, v60, v61
    v_cvt_pk_bf16_f32 v83, v62, v63
    s_mov_b32 exec_lo, 0
    s_mov_b32 exec_hi, 0xffff
    ds_write_b16 v145, v82 offset:784
    ds_write_b16_d16_hi v145, v82 offset:800
    ds_write_b16 v145, v83 offset:21264
    ds_write_b16_d16_hi v145, v83 offset:21280
    s_mov_b32 exec_hi, 0xffff0000
    v_mov_b32 v82, v60
    v_mov_b32 v83, v60
    s_mov_b32 exec_lo, -1
    ds_write_b32 v145, v82 offset:256
    ds_write_b32 v145, v83 offset:20736
    s_mov_b64 exec, -1
    v_max3_f32 v90, v8, v9, v10
    v_max3_f32 v90, v90, v11, v12
    v_max3_f32 v90, v90, v13, v14
    v_max3_f32 v90, v90, v15, v16
    v_max3_f32 v90, v90, v17, v18
    v_max3_f32 v90, v90, v19, v20
    v_max3_f32 v90, v90, v21, v22
    v_max_f32 v90, v90, v23
    v_max3_f32 v91, v24, v25, v26
    v_max3_f32 v91, v91, v27, v28
    v_max3_f32 v91, v91, v29, v30
    v_max3_f32 v91, v91, v31, v32
    v_max3_f32 v91, v91, v33, v34
    v_max3_f32 v91, v91, v35, v36
    v_max3_f32 v91, v91, v37, v38
    v_max_f32 v91, v91, v39
    v_lshrrev_b32 v5, 5, v1
    s_lshr_b32 s29, s24, 2
    v_xor_b32 v5, s29, v5
    v_lshl_add_u32 v7, v5, 3, v161
    v_add_u32 v7, s66, v7
    v_mov_b32 v132, 0xdddddddd
    v_mov_b32 v133, v160
    v_mov_b32 v134, v161
    v_mov_b32 v135, v162
    v_permlane32_swap_b32 v90, v91
    v_max_f32 v90, v90, v91
    v_cvt_pk_bf16_f32 v149, -v90, 0
    s_waitcnt lgkmcnt(0)
    s_barrier
    ds_read_b64 v[112:113], v7
    ds_read_b128 v[120:123], v161
    ds_read_b128 v[116:119], v160
    ds_read_b128 v[124:127], v135
    s_lshl_b32 s29, s27, 31
    s_xor_b32 s29, s29, 0xbfb8aa3b
    s_lshl_b32 s39, s26, 3
    s_mul_i32 s39, s39, 40960
    s_mov_b64 s[68:69], -1
    s_mov_b32 s37, 0
    s_mov_b32 s66, 0
    s_waitcnt lgkmcnt(3)
    v_mul_f32 v136, s29, v113
    v_mov_b32 v113, v149
    v_exp_f32 v136, v136
    s_waitcnt lgkmcnt(2)
    v_mfma_f32_32x32x4_2b_bf16 v[8:39], v[120:121], v[112:113], 0
    v_add_f32 v136, 1.0, v136
    v_rcp_f32 v136, v136
    v_mov_b32 v64, 0
    v_mov_b32 v65, 0
    v_mov_b32 v66, 0
    v_mov_b32 v67, 0
    v_mov_b32 v68, 0
    v_mov_b32 v69, 0
    v_mov_b32 v70, 0
    v_mov_b32 v71, 0
    v_mov_b32 v128, 0
    v_mov_b32 v129, 0
    v_mov_b32 v130, 0
    v_mov_b32 v131, 0
    v_mov_b32 v72, 0
    v_mov_b32 v73, 0
    v_mov_b32 v74, 0
    v_mov_b32 v75, 0
    s_waitcnt lgkmcnt(1)
    v_mfma_f32_32x32x16_bf16 v[8:23], v[116:119], v[104:107], v[8:23]
    v_mfma_f32_32x32x16_bf16 v[24:39], v[116:119], v[108:111], v[24:39]
    ds_read_b128 v[116:119], v133 offset:1024
    v_mov_b32 v76, 0
    v_mov_b32 v77, 0
    v_mov_b32 v78, 0
    v_mov_b32 v79, 0
    v_mov_b32 v80, 0
    v_mov_b32 v81, 0
    v_mov_b32 v82, 0
    v_mov_b32 v83, 0
    v_mov_b32 v84, 0
    v_mov_b32 v85, 0
    v_mov_b32 v86, 0
    v_mov_b32 v87, 0
    v_mov_b32 v88, 0
    v_mov_b32 v89, 0
    v_mov_b32 v90, 0
    v_mov_b32 v91, 0
    v_mov_b32 v92, 0
    v_mov_b32 v93, 0
    v_mov_b32 v94, 0
    v_mov_b32 v95, 0
    v_mov_b32 v96, 0
    v_mov_b32 v97, 0
    v_mov_b32 v98, 0
    v_mov_b32 v99, 0
    v_mov_b32 v100, 0
    v_mov_b32 v101, 0
    v_mov_b32 v102, 0
    v_mov_b32 v103, 0
L_att_loop:
    s_setprio 2
    v_exp_f32 v8, v8
    v_exp_f32 v9, v9
    v_exp_f32 v10, v10
    v_smfmac_f32_32x32x32_bf16 v[88:103], v[128:131], v[64:71], v132
    ds_read_b128 v[128:131], v135 offset:640
    v_exp_f32 v11, v11
    v_exp_f32 v12, v12
    v_exp_f32 v13, v13
    v_mfma_f32_32x32x4_2b_bf16 v[40:71], v[122:123], v[112:113], 0
    ds_read_b128 v[120:123], v134 offset:5120
    v_exp_f32 v14, v14
    v_exp_f32 v15, v15
    v_exp_f32 v16, v16
    v_exp_f32 v17, v17
    v_exp_f32 v18, v18
    v_exp_f32 v19, v19
    v_exp_f32 v20, v20
    v_exp_f32 v21, v21
    s_waitcnt lgkmcnt(0)
    v_smfmac_f32_32x32x32_bf16 v[72:87], v[124:127], v[8:15], v132
    v_exp_f32 v22, v22
    v_exp_f32 v23, v23
    v_exp_f32 v24, v24
    v_exp_f32 v25, v25
    v_smfmac_f32_32x32x32_bf16 v[72:87], v[128:131], v[16:23], v132
    v_exp_f32 v26, v26
    v_exp_f32 v27, v27
    v_exp_f32 v28, v28
    v_exp_f32 v29, v29
    v_mfma_f32_32x32x16_bf16 v[40:55], v[116:119], v[104:107], v[40:55]
    v_exp_f32 v30, v30
    v_exp_f32 v31, v31
    v_exp_f32 v32, v32
    v_exp_f32 v33, v33
    v_smfmac_f32_32x32x32_bf16 v[88:103], v[124:127], v[24:31], v132
    ds_read_b128 v[124:127], v135 offset:1280
    v_exp_f32 v34, v34
    v_exp_f32 v35, v35
    v_exp_f32 v36, v36
    v_mfma_f32_32x32x16_bf16 v[56:71], v[116:119], v[108:111], v[56:71]
    ds_read_b128 v[116:119], v133 offset:5120
    v_exp_f32 v37, v37
    v_exp_f32 v38, v38
    v_exp_f32 v39, v39
    v_exp_f32 v40, v40
    v_exp_f32 v41, v41
    v_exp_f32 v42, v42
    v_smfmac_f32_32x32x32_bf16 v[88:103], v[128:131], v[32:39], v132
    ds_read_b128 v[128:131], v135 offset:1920
    v_exp_f32 v43, v43
    v_exp_f32 v44, v44
    v_exp_f32 v45, v45
    v_mfma_f32_32x32x4_2b_bf16 v[8:39], v[120:121], v[112:113], 0
    v_exp_f32 v46, v46
    v_exp_f32 v47, v47
    v_exp_f32 v48, v48
    v_exp_f32 v49, v49
    v_exp_f32 v50, v50
    v_exp_f32 v51, v51
    v_exp_f32 v52, v52
    v_exp_f32 v53, v53
    s_waitcnt lgkmcnt(0)
    v_smfmac_f32_32x32x32_bf16 v[72:87], v[124:127], v[40:47], v132
    v_exp_f32 v54, v54
    v_exp_f32 v55, v55
    v_exp_f32 v56, v56
    v_exp_f32 v57, v57
    v_smfmac_f32_32x32x32_bf16 v[72:87], v[128:131], v[48:55], v132
    v_exp_f32 v58, v58
    v_exp_f32 v59, v59
    v_exp_f32 v60, v60
    v_exp_f32 v61, v61
    v_mfma_f32_32x32x16_bf16 v[8:23], v[116:119], v[104:107], v[8:23]
    v_exp_f32 v62, v62
    v_exp_f32 v63, v63
    v_exp_f32 v64, v64
    v_exp_f32 v65, v65
    v_smfmac_f32_32x32x32_bf16 v[88:103], v[124:127], v[56:63], v132
    ds_read_b128 v[124:127], v135 offset:5120
    v_exp_f32 v66, v66
    v_exp_f32 v67, v67
    v_exp_f32 v68, v68
    v_mfma_f32_32x32x16_bf16 v[24:39], v[116:119], v[108:111], v[24:39]
    ds_read_b128 v[116:119], v133 offset:6144
    v_exp_f32 v69, v69
    v_exp_f32 v70, v70
    v_exp_f32 v71, v71
    s_setprio 1
    v_exp_f32 v8, v8
    v_exp_f32 v9, v9
    v_exp_f32 v10, v10
    v_smfmac_f32_32x32x32_bf16 v[88:103], v[128:131], v[64:71], v132
    ds_read_b128 v[128:131], v135 offset:5760
    v_exp_f32 v11, v11
    v_exp_f32 v12, v12
    v_exp_f32 v13, v13
    v_mfma_f32_32x32x4_2b_bf16 v[40:71], v[122:123], v[112:113], 0
    ds_read_b128 v[120:123], v134 offset:10240
    v_exp_f32 v14, v14
    v_exp_f32 v15, v15
    v_exp_f32 v16, v16
    v_exp_f32 v17, v17
    v_exp_f32 v18, v18
    v_exp_f32 v19, v19
    v_exp_f32 v20, v20
    v_exp_f32 v21, v21
    s_waitcnt lgkmcnt(0)
    v_smfmac_f32_32x32x32_bf16 v[72:87], v[124:127], v[8:15], v132
    v_exp_f32 v22, v22
    v_exp_f32 v23, v23
    v_exp_f32 v24, v24
    v_exp_f32 v25, v25
    v_smfmac_f32_32x32x32_bf16 v[72:87], v[128:131], v[16:23], v132
    v_exp_f32 v26, v26
    v_exp_f32 v27, v27
    v_exp_f32 v28, v28
    v_exp_f32 v29, v29
    v_mfma_f32_32x32x16_bf16 v[40:55], v[116:119], v[104:107], v[40:55]
    v_exp_f32 v30, v30
    v_exp_f32 v31, v31
    v_exp_f32 v32, v32
    v_exp_f32 v33, v33
    v_smfmac_f32_32x32x32_bf16 v[88:103], v[124:127], v[24:31], v132
    ds_read_b128 v[124:127], v135 offset:6400
    v_exp_f32 v34, v34
    v_exp_f32 v35, v35
    v_exp_f32 v36, v36
    v_mfma_f32_32x32x16_bf16 v[56:71], v[116:119], v[108:111], v[56:71]
    ds_read_b128 v[116:119], v133 offset:10240
    v_exp_f32 v37, v37
    v_exp_f32 v38, v38
    v_exp_f32 v39, v39
    v_exp_f32 v40, v40
    v_exp_f32 v41, v41
    v_exp_f32 v42, v42
    v_smfmac_f32_32x32x32_bf16 v[88:103], v[128:131], v[32:39], v132
    ds_read_b128 v[128:131], v135 offset:7040
    v_exp_f32 v43, v43
    v_exp_f32 v44, v44
    v_exp_f32 v45, v45
    v_mfma_f32_32x32x4_2b_bf16 v[8:39], v[120:121], v[112:113], 0
    v_exp_f32 v46, v46
    v_exp_f32 v47, v47
    v_exp_f32 v48, v48
    v_exp_f32 v49, v49
    v_exp_f32 v50, v50
    v_exp_f32 v51, v51
    v_exp_f32 v52, v52
    v_exp_f32 v53, v53
    s_waitcnt lgkmcnt(0)
    v_smfmac_f32_32x32x32_bf16 v[72:87], v[124:127], v[40:47], v132
    v_exp_f32 v54, v54
    v_exp_f32 v55, v55
    v_exp_f32 v56, v56
    v_exp_f32 v57, v57
    v_smfmac_f32_32x32x32_bf16 v[72:87], v[128:131], v[48:55], v132
    v_exp_f32 v58, v58
    v_exp_f32 v59, v59
    v_exp_f32 v60, v60
    v_exp_f32 v61, v61
    v_mfma_f32_32x32x16_bf16 v[8:23], v[116:119], v[104:107], v[8:23]
    v_exp_f32 v62, v62
    v_exp_f32 v63, v63
    v_exp_f32 v64, v64
    v_exp_f32 v65, v65
    v_smfmac_f32_32x32x32_bf16 v[88:103], v[124:127], v[56:63], v132
    ds_read_b128 v[124:127], v135 offset:10240
    v_exp_f32 v66, v66
    v_exp_f32 v67, v67
    v_exp_f32 v68, v68
    v_mfma_f32_32x32x16_bf16 v[24:39], v[116:119], v[108:111], v[24:39]
    ds_read_b128 v[116:119], v133 offset:11264
    v_exp_f32 v69, v69
    v_exp_f32 v70, v70
    v_exp_f32 v71, v71
    s_setprio 0
    v_exp_f32 v8, v8
    v_exp_f32 v9, v9
    v_exp_f32 v10, v10
    v_smfmac_f32_32x32x32_bf16 v[88:103], v[128:131], v[64:71], v132
    ds_read_b128 v[128:131], v135 offset:10880
    v_exp_f32 v11, v11
    v_exp_f32 v12, v12
    v_exp_f32 v13, v13
    v_mfma_f32_32x32x4_2b_bf16 v[40:71], v[122:123], v[112:113], 0
    ds_read_b128 v[120:123], v134 offset:15360
    v_exp_f32 v14, v14
    v_exp_f32 v15, v15
    v_exp_f32 v16, v16
    v_exp_f32 v17, v17
    v_exp_f32 v18, v18
    v_exp_f32 v19, v19
    v_exp_f32 v20, v20
    v_exp_f32 v21, v21
    s_waitcnt lgkmcnt(0)
    v_smfmac_f32_32x32x32_bf16 v[72:87], v[124:127], v[8:15], v132
    v_exp_f32 v22, v22
    v_exp_f32 v23, v23
    v_exp_f32 v24, v24
    v_exp_f32 v25, v25
    v_smfmac_f32_32x32x32_bf16 v[72:87], v[128:131], v[16:23], v132
    v_exp_f32 v26, v26
    v_exp_f32 v27, v27
    v_exp_f32 v28, v28
    v_exp_f32 v29, v29
    v_mfma_f32_32x32x16_bf16 v[40:55], v[116:119], v[104:107], v[40:55]
    v_exp_f32 v30, v30
    v_exp_f32 v31, v31
    v_exp_f32 v32, v32
    v_exp_f32 v33, v33
    v_smfmac_f32_32x32x32_bf16 v[88:103], v[124:127], v[24:31], v132
    ds_read_b128 v[124:127], v135 offset:11520
    v_exp_f32 v34, v34
    v_exp_f32 v35, v35
    v_exp_f32 v36, v36
    v_mfma_f32_32x32x16_bf16 v[56:71], v[116:119], v[108:111], v[56:71]
    ds_read_b128 v[116:119], v133 offset:15360
    v_exp_f32 v37, v37
    v_exp_f32 v38, v38
    v_exp_f32 v39, v39
    v_exp_f32 v40, v40
    v_exp_f32 v41, v41
    v_exp_f32 v42, v42
    v_smfmac_f32_32x32x32_bf16 v[88:103], v[128:131], v[32:39], v132
    ds_read_b128 v[128:131], v135 offset:12160
    v_exp_f32 v43, v43
    v_exp_f32 v44, v44
    v_exp_f32 v45, v45
    v_mfma_f32_32x32x4_2b_bf16 v[8:39], v[120:121], v[112:113], 0
    v_exp_f32 v46, v46
    v_exp_f32 v47, v47
    v_exp_f32 v48, v48
    v_exp_f32 v49, v49
    v_exp_f32 v50, v50
    v_exp_f32 v51, v51
    v_exp_f32 v52, v52
    v_exp_f32 v53, v53
    s_waitcnt lgkmcnt(0)
    v_smfmac_f32_32x32x32_bf16 v[72:87], v[124:127], v[40:47], v132
    v_exp_f32 v54, v54
    v_exp_f32 v55, v55
    v_exp_f32 v56, v56
    v_exp_f32 v57, v57
    v_smfmac_f32_32x32x32_bf16 v[72:87], v[128:131], v[48:55], v132
    v_exp_f32 v58, v58
    v_exp_f32 v59, v59
    v_exp_f32 v60, v60
    v_exp_f32 v61, v61
    v_mfma_f32_32x32x16_bf16 v[8:23], v[116:119], v[104:107], v[8:23]
    v_exp_f32 v62, v62
    v_exp_f32 v63, v63
    v_exp_f32 v64, v64
    v_exp_f32 v65, v65
    v_smfmac_f32_32x32x32_bf16 v[88:103], v[124:127], v[56:63], v132
    ds_read_b128 v[124:127], v135 offset:15360
    v_exp_f32 v66, v66
    v_exp_f32 v67, v67
    v_exp_f32 v68, v68
    v_mfma_f32_32x32x16_bf16 v[24:39], v[116:119], v[108:111], v[24:39]
    ds_read_b128 v[116:119], v133 offset:16384
    v_exp_f32 v69, v69
    v_exp_f32 v70, v70
    v_exp_f32 v71, v71
    v_exp_f32 v8, v8
    v_exp_f32 v9, v9
    v_exp_f32 v10, v10
    v_smfmac_f32_32x32x32_bf16 v[88:103], v[128:131], v[64:71], v132
    ds_read_b128 v[128:131], v135 offset:16000
    v_exp_f32 v11, v11
    v_exp_f32 v12, v12
    v_exp_f32 v13, v13
    s_add_u32 s66, s66, 40960
    s_cmp_eq_u32 s66, 163840
    s_cselect_b32 s66, 0, s66
    s_barrier
    s_setprio 3
    v_add_u32 v134, s66, v161
    v_add_u32 v133, s66, v160
    v_mfma_f32_32x32x4_2b_bf16 v[40:71], v[122:123], v[112:113], 0
    ds_read_b128 v[120:123], v134 offset:0
    v_exp_f32 v14, v14
    v_exp_f32 v15, v15
    v_exp_f32 v16, v16
    v_exp_f32 v17, v17
    v_exp_f32 v18, v18
    v_exp_f32 v19, v19
    v_exp_f32 v20, v20
    v_exp_f32 v21, v21
    s_waitcnt lgkmcnt(0)
    v_smfmac_f32_32x32x32_bf16 v[72:87], v[124:127], v[8:15], v132
    v_exp_f32 v22, v22
    v_exp_f32 v23, v23
    v_exp_f32 v24, v24
    v_exp_f32 v25, v25
    v_smfmac_f32_32x32x32_bf16 v[72:87], v[128:131], v[16:23], v132
    v_exp_f32 v26, v26
    v_exp_f32 v27, v27
    v_exp_f32 v28, v28
    v_exp_f32 v29, v29
    v_mfma_f32_32x32x16_bf16 v[40:55], v[116:119], v[104:107], v[40:55]
    v_exp_f32 v30, v30
    v_exp_f32 v31, v31
    v_exp_f32 v32, v32
    v_exp_f32 v33, v33
    v_smfmac_f32_32x32x32_bf16 v[88:103], v[124:127], v[24:31], v132
    ds_read_b128 v[124:127], v135 offset:16640
    v_exp_f32 v34, v34
    v_exp_f32 v35, v35
    v_exp_f32 v36, v36
    v_mfma_f32_32x32x16_bf16 v[56:71], v[116:119], v[108:111], v[56:71]
    ds_read_b128 v[116:119], v133 offset:0
    v_exp_f32 v37, v37
    v_exp_f32 v38, v38
    v_exp_f32 v39, v39
    v_exp_f32 v40, v40
    v_exp_f32 v41, v41
    v_exp_f32 v42, v42
    v_smfmac_f32_32x32x32_bf16 v[88:103], v[128:131], v[32:39], v132
    ds_read_b128 v[128:131], v135 offset:17280
    v_exp_f32 v43, v43
    v_exp_f32 v44, v44
    v_exp_f32 v45, v45
    v_mfma_f32_32x32x4_2b_bf16 v[8:39], v[120:121], v[112:113], 0
    v_exp_f32 v46, v46
    v_exp_f32 v47, v47
    v_exp_f32 v48, v48
    v_exp_f32 v49, v49
    v_exp_f32 v50, v50
    v_exp_f32 v51, v51
    v_exp_f32 v52, v52
    v_exp_f32 v53, v53
    s_waitcnt lgkmcnt(0)
    v_smfmac_f32_32x32x32_bf16 v[72:87], v[124:127], v[40:47], v132
    v_exp_f32 v54, v54
    v_exp_f32 v55, v55
    v_exp_f32 v56, v56
    v_exp_f32 v57, v57
    v_smfmac_f32_32x32x32_bf16 v[72:87], v[128:131], v[48:55], v132
    v_exp_f32 v58, v58
    v_exp_f32 v59, v59
    v_exp_f32 v60, v60
    v_exp_f32 v61, v61
    v_mfma_f32_32x32x16_bf16 v[8:23], v[116:119], v[104:107], v[8:23]
    v_exp_f32 v62, v62
    v_exp_f32 v63, v63
    v_exp_f32 v64, v64
    v_exp_f32 v65, v65
    v_smfmac_f32_32x32x32_bf16 v[88:103], v[124:127], v[56:63], v132
    v_add_u32 v135, s66, v162
    ds_read_b128 v[124:127], v135 offset:0
    v_exp_f32 v66, v66
    v_exp_f32 v67, v67
    v_exp_f32 v68, v68
    v_mfma_f32_32x32x16_bf16 v[24:39], v[116:119], v[108:111], v[24:39]
    ds_read_b128 v[116:119], v133 offset:1024
    v_exp_f32 v69, v69
    v_exp_f32 v70, v70
    v_exp_f32 v71, v71
    s_add_u32 s37, s37, 1
    s_cmp_lt_u32 s37, 7
    s_cbranch_scc1 L_att_loop
    s_setprio 0
    v_exp_f32 v8, v8
    v_exp_f32 v9, v9
    v_exp_f32 v10, v10
    v_smfmac_f32_32x32x32_bf16 v[88:103], v[128:131], v[64:71], v132
    ds_read_b128 v[128:131], v135 offset:640
    v_exp_f32 v11, v11
    v_exp_f32 v12, v12
    v_exp_f32 v13, v13
    v_mfma_f32_32x32x4_2b_bf16 v[40:71], v[122:123], v[112:113], 0
    ds_read_b128 v[120:123], v134 offset:5120
    v_exp_f32 v14, v14
    v_exp_f32 v15, v15
    v_exp_f32 v16, v16
    v_exp_f32 v17, v17
    v_exp_f32 v18, v18
    v_exp_f32 v19, v19
    v_exp_f32 v20, v20
    v_exp_f32 v21, v21
    s_waitcnt lgkmcnt(0)
    v_smfmac_f32_32x32x32_bf16 v[72:87], v[124:127], v[8:15], v132
    v_exp_f32 v22, v22
    v_exp_f32 v23, v23
    v_exp_f32 v24, v24
    v_exp_f32 v25, v25
    v_smfmac_f32_32x32x32_bf16 v[72:87], v[128:131], v[16:23], v132
    v_exp_f32 v26, v26
    v_exp_f32 v27, v27
    v_exp_f32 v28, v28
    v_exp_f32 v29, v29
    v_mfma_f32_32x32x16_bf16 v[40:55], v[116:119], v[104:107], v[40:55]
    v_exp_f32 v30, v30
    v_exp_f32 v31, v31
    v_exp_f32 v32, v32
    v_exp_f32 v33, v33
    v_smfmac_f32_32x32x32_bf16 v[88:103], v[124:127], v[24:31], v132
    ds_read_b128 v[124:127], v135 offset:1280
    v_exp_f32 v34, v34
    v_exp_f32 v35, v35
    v_exp_f32 v36, v36
    v_mfma_f32_32x32x16_bf16 v[56:71], v[116:119], v[108:111], v[56:71]
    ds_read_b128 v[116:119], v133 offset:5120
    v_exp_f32 v37, v37
    v_exp_f32 v38, v38
    v_exp_f32 v39, v39
    s_barrier
    s_setprio 2
    v_exp_f32 v40, v40
    v_exp_f32 v41, v41
    v_exp_f32 v42, v42
    v_smfmac_f32_32x32x32_bf16 v[88:103], v[128:131], v[32:39], v132
    ds_read_b128 v[128:131], v135 offset:1920
    v_exp_f32 v43, v43
    v_exp_f32 v44, v44
    v_exp_f32 v45, v45
    v_mfma_f32_32x32x4_2b_bf16 v[8:39], v[120:121], v[112:113], 0
    v_exp_f32 v46, v46
    v_exp_f32 v47, v47
    v_exp_f32 v48, v48
    v_exp_f32 v49, v49
    v_exp_f32 v50, v50
    v_exp_f32 v51, v51
    v_exp_f32 v52, v52
    v_exp_f32 v53, v53
    s_waitcnt lgkmcnt(0)
    v_smfmac_f32_32x32x32_bf16 v[72:87], v[124:127], v[40:47], v132
    v_exp_f32 v54, v54
    v_exp_f32 v55, v55
    v_exp_f32 v56, v56
    v_exp_f32 v57, v57
    v_smfmac_f32_32x32x32_bf16 v[72:87], v[128:131], v[48:55], v132
    v_exp_f32 v58, v58
    v_exp_f32 v59, v59
    v_exp_f32 v60, v60
    v_exp_f32 v61, v61
    v_mfma_f32_32x32x16_bf16 v[8:23], v[116:119], v[104:107], v[8:23]
    v_exp_f32 v62, v62
    v_exp_f32 v63, v63
    v_exp_f32 v64, v64
    v_exp_f32 v65, v65
    v_smfmac_f32_32x32x32_bf16 v[88:103], v[124:127], v[56:63], v132
    ds_read_b128 v[124:127], v135 offset:5120
    v_exp_f32 v66, v66
    v_exp_f32 v67, v67
    v_exp_f32 v68, v68
    v_mfma_f32_32x32x16_bf16 v[24:39], v[116:119], v[108:111], v[24:39]
    ds_read_b128 v[116:119], v133 offset:6144
    v_exp_f32 v69, v69
    v_exp_f32 v70, v70
    v_exp_f32 v71, v71
    s_setprio 1
    v_exp_f32 v8, v8
    v_exp_f32 v9, v9
    v_exp_f32 v10, v10
    v_smfmac_f32_32x32x32_bf16 v[88:103], v[128:131], v[64:71], v132
    ds_read_b128 v[128:131], v135 offset:5760
    v_exp_f32 v11, v11
    v_exp_f32 v12, v12
    v_exp_f32 v13, v13
    v_mfma_f32_32x32x4_2b_bf16 v[40:71], v[122:123], v[112:113], 0
    ds_read_b128 v[120:123], v134 offset:10240
    v_exp_f32 v14, v14
    v_exp_f32 v15, v15
    v_exp_f32 v16, v16
    v_exp_f32 v17, v17
    v_exp_f32 v18, v18
    v_exp_f32 v19, v19
    v_exp_f32 v20, v20
    v_exp_f32 v21, v21
    s_waitcnt lgkmcnt(0)
    v_smfmac_f32_32x32x32_bf16 v[72:87], v[124:127], v[8:15], v132
    v_exp_f32 v22, v22
    v_exp_f32 v23, v23
    v_exp_f32 v24, v24
    v_exp_f32 v25, v25
    v_smfmac_f32_32x32x32_bf16 v[72:87], v[128:131], v[16:23], v132
    v_exp_f32 v26, v26
    v_exp_f32 v27, v27
    v_exp_f32 v28, v28
    v_exp_f32 v29, v29
    v_mfma_f32_32x32x16_bf16 v[40:55], v[116:119], v[104:107], v[40:55]
    v_exp_f32 v30, v30
    v_exp_f32 v31, v31
    v_exp_f32 v32, v32
    v_exp_f32 v33, v33
    v_smfmac_f32_32x32x32_bf16 v[88:103], v[124:127], v[24:31], v132
    ds_read_b128 v[124:127], v135 offset:6400
    v_exp_f32 v34, v34
    v_exp_f32 v35, v35
    v_exp_f32 v36, v36
    v_mfma_f32_32x32x16_bf16 v[56:71], v[116:119], v[108:111], v[56:71]
    ds_read_b128 v[116:119], v133 offset:10240
    v_exp_f32 v37, v37
    v_exp_f32 v38, v38
    v_exp_f32 v39, v39
    s_setprio 0
    v_exp_f32 v40, v40
    v_exp_f32 v41, v41
    v_exp_f32 v42, v42
    v_smfmac_f32_32x32x32_bf16 v[88:103], v[128:131], v[32:39], v132
    ds_read_b128 v[128:131], v135 offset:7040
    v_exp_f32 v43, v43
    v_exp_f32 v44, v44
    v_exp_f32 v45, v45
    v_mfma_f32_32x32x4_2b_bf16 v[8:39], v[120:121], v[112:113], 0
    v_exp_f32 v46, v46
    v_exp_f32 v47, v47
    v_exp_f32 v48, v48
    v_exp_f32 v49, v49
    v_exp_f32 v50, v50
    v_exp_f32 v51, v51
    v_exp_f32 v52, v52
    v_exp_f32 v53, v53
    s_waitcnt lgkmcnt(0)
    v_smfmac_f32_32x32x32_bf16 v[72:87], v[124:127], v[40:47], v132
    v_exp_f32 v54, v54
    v_exp_f32 v55, v55
    v_exp_f32 v56, v56
    v_exp_f32 v57, v57
    v_smfmac_f32_32x32x32_bf16 v[72:87], v[128:131], v[48:55], v132
    v_exp_f32 v58, v58
    v_exp_f32 v59, v59
    v_exp_f32 v60, v60
    v_exp_f32 v61, v61
    v_mfma_f32_32x32x16_bf16 v[8:23], v[116:119], v[104:107], v[8:23]
    v_exp_f32 v62, v62
    v_exp_f32 v63, v63
    v_exp_f32 v64, v64
    v_exp_f32 v65, v65
    v_smfmac_f32_32x32x32_bf16 v[88:103], v[124:127], v[56:63], v132
    ds_read_b128 v[124:127], v135 offset:10240
    v_exp_f32 v66, v66
    v_exp_f32 v67, v67
    v_exp_f32 v68, v68
    v_mfma_f32_32x32x16_bf16 v[24:39], v[116:119], v[108:111], v[24:39]
    ds_read_b128 v[116:119], v133 offset:11264
    v_exp_f32 v69, v69
    v_exp_f32 v70, v70
    v_exp_f32 v71, v71
    s_barrier
    s_setprio 1
    v_exp_f32 v8, v8
    v_exp_f32 v9, v9
    v_exp_f32 v10, v10
    v_smfmac_f32_32x32x32_bf16 v[88:103], v[128:131], v[64:71], v132
    ds_read_b128 v[128:131], v135 offset:10880
    v_exp_f32 v11, v11
    v_exp_f32 v12, v12
    v_exp_f32 v13, v13
    v_mfma_f32_32x32x4_2b_bf16 v[40:71], v[122:123], v[112:113], 0
    ds_read_b128 v[120:123], v134 offset:15360
    v_exp_f32 v14, v14
    v_exp_f32 v15, v15
    v_exp_f32 v16, v16
    v_exp_f32 v17, v17
    v_exp_f32 v18, v18
    v_exp_f32 v19, v19
    v_exp_f32 v20, v20
    v_exp_f32 v21, v21
    s_waitcnt lgkmcnt(0)
    v_smfmac_f32_32x32x32_bf16 v[72:87], v[124:127], v[8:15], v132
    v_exp_f32 v22, v22
    v_exp_f32 v23, v23
    v_exp_f32 v24, v24
    v_exp_f32 v25, v25
    v_smfmac_f32_32x32x32_bf16 v[72:87], v[128:131], v[16:23], v132
    v_exp_f32 v26, v26
    v_exp_f32 v27, v27
    v_exp_f32 v28, v28
    v_exp_f32 v29, v29
    v_mfma_f32_32x32x16_bf16 v[40:55], v[116:119], v[104:107], v[40:55]
    v_exp_f32 v30, v30
    v_exp_f32 v31, v31
    v_exp_f32 v32, v32
    v_exp_f32 v33, v33
    v_smfmac_f32_32x32x32_bf16 v[88:103], v[124:127], v[24:31], v132
    ds_read_b128 v[124:127], v135 offset:11520
    v_exp_f32 v34, v34
    v_exp_f32 v35, v35
    v_exp_f32 v36, v36
    v_mfma_f32_32x32x16_bf16 v[56:71], v[116:119], v[108:111], v[56:71]
    ds_read_b128 v[116:119], v133 offset:15360
    v_exp_f32 v37, v37
    v_exp_f32 v38, v38
    v_exp_f32 v39, v39
    s_setprio 0
    v_exp_f32 v40, v40
    v_exp_f32 v41, v41
    v_exp_f32 v42, v42
    v_smfmac_f32_32x32x32_bf16 v[88:103], v[128:131], v[32:39], v132
    ds_read_b128 v[128:131], v135 offset:12160
    v_exp_f32 v43, v43
    v_exp_f32 v44, v44
    v_exp_f32 v45, v45
    v_mfma_f32_32x32x4_2b_bf16 v[8:39], v[120:121], v[112:113], 0
    v_exp_f32 v46, v46
    v_exp_f32 v47, v47
    v_exp_f32 v48, v48
    v_exp_f32 v49, v49
    v_exp_f32 v50, v50
    v_exp_f32 v51, v51
    v_exp_f32 v52, v52
    v_exp_f32 v53, v53
    s_waitcnt lgkmcnt(0)
    v_smfmac_f32_32x32x32_bf16 v[72:87], v[124:127], v[40:47], v132
    v_exp_f32 v54, v54
    v_exp_f32 v55, v55
    v_exp_f32 v56, v56
    v_exp_f32 v57, v57
    v_smfmac_f32_32x32x32_bf16 v[72:87], v[128:131], v[48:55], v132
    v_exp_f32 v58, v58
    v_exp_f32 v59, v59
    v_exp_f32 v60, v60
    v_exp_f32 v61, v61
    v_mfma_f32_32x32x16_bf16 v[8:23], v[116:119], v[104:107], v[8:23]
    v_exp_f32 v62, v62
    v_exp_f32 v63, v63
    v_exp_f32 v64, v64
    v_exp_f32 v65, v65
    v_smfmac_f32_32x32x32_bf16 v[88:103], v[124:127], v[56:63], v132
    ds_read_b128 v[124:127], v135 offset:15360
    v_exp_f32 v66, v66
    v_exp_f32 v67, v67
    v_exp_f32 v68, v68
    v_mfma_f32_32x32x16_bf16 v[24:39], v[116:119], v[108:111], v[24:39]
    ds_read_b128 v[116:119], v133 offset:16384
    v_exp_f32 v69, v69
    v_exp_f32 v70, v70
    v_exp_f32 v71, v71
    s_barrier
    s_setprio 1
    v_exp_f32 v8, v8
    v_exp_f32 v9, v9
    v_exp_f32 v10, v10
    v_smfmac_f32_32x32x32_bf16 v[88:103], v[128:131], v[64:71], v132
    ds_read_b128 v[128:131], v135 offset:16000
    v_exp_f32 v11, v11
    v_exp_f32 v12, v12
    v_exp_f32 v13, v13
    v_mfma_f32_32x32x4_2b_bf16 v[40:71], v[122:123], v[112:113], 0
    v_exp_f32 v14, v14
    v_exp_f32 v15, v15
    v_exp_f32 v16, v16
    v_exp_f32 v17, v17
    v_exp_f32 v18, v18
    v_exp_f32 v19, v19
    v_exp_f32 v20, v20
    v_exp_f32 v21, v21
    s_waitcnt lgkmcnt(0)
    v_smfmac_f32_32x32x32_bf16 v[72:87], v[124:127], v[8:15], v132
    v_exp_f32 v22, v22
    v_exp_f32 v23, v23
    v_exp_f32 v24, v24
    v_exp_f32 v25, v25
    v_smfmac_f32_32x32x32_bf16 v[72:87], v[128:131], v[16:23], v132
    v_exp_f32 v26, v26
    v_exp_f32 v27, v27
    v_exp_f32 v28, v28
    v_exp_f32 v29, v29
    s_setprio 0
    v_mfma_f32_32x32x16_bf16 v[40:55], v[116:119], v[104:107], v[40:55]
    v_exp_f32 v30, v30
    v_exp_f32 v31, v31
    v_exp_f32 v32, v32
    v_exp_f32 v33, v33
    v_smfmac_f32_32x32x32_bf16 v[88:103], v[124:127], v[24:31], v132
    ds_read_b128 v[124:127], v135 offset:16640
    v_exp_f32 v34, v34
    v_exp_f32 v35, v35
    v_exp_f32 v36, v36
    v_mfma_f32_32x32x16_bf16 v[56:71], v[116:119], v[108:111], v[56:71]
    v_exp_f32 v37, v37
    v_exp_f32 v38, v38
    v_exp_f32 v39, v39
    v_exp_f32 v40, v40
    v_exp_f32 v41, v41
    v_exp_f32 v42, v42
    v_smfmac_f32_32x32x32_bf16 v[88:103], v[128:131], v[32:39], v132
    ds_read_b128 v[128:131], v135 offset:17280
    v_exp_f32 v43, v43
    v_exp_f32 v44, v44
    v_exp_f32 v45, v45
    v_exp_f32 v46, v46
    v_exp_f32 v47, v47
    v_exp_f32 v48, v48
    v_exp_f32 v49, v49
    v_exp_f32 v50, v50
    v_exp_f32 v51, v51
    v_exp_f32 v52, v52
    v_exp_f32 v53, v53
    s_waitcnt lgkmcnt(0)
    s_barrier
    s_setprio 0
    v_smfmac_f32_32x32x32_bf16 v[72:87], v[124:127], v[40:47], v132
    v_exp_f32 v54, v54
    v_exp_f32 v55, v55
    v_exp_f32 v56, v56
    v_exp_f32 v57, v57
    v_smfmac_f32_32x32x32_bf16 v[72:87], v[128:131], v[48:55], v132
    v_exp_f32 v58, v58
    v_exp_f32 v59, v59
    v_exp_f32 v60, v60
    v_exp_f32 v61, v61
    v_exp_f32 v62, v62
    v_exp_f32 v63, v63
    v_exp_f32 v64, v64
    v_exp_f32 v65, v65
    v_smfmac_f32_32x32x32_bf16 v[88:103], v[124:127], v[56:63], v132
    v_exp_f32 v66, v66
    v_exp_f32 v67, v67
    v_exp_f32 v68, v68
    v_exp_f32 v69, v69
    v_exp_f32 v70, v70
    v_exp_f32 v71, v71
    s_nop 1
    v_smfmac_f32_32x32x32_bf16 v[88:103], v[128:131], v[64:71], v132
L_att_norm:
    ds_read_b64_tr_b16 v[8:9], v163 offset:0
    ds_read_b64_tr_b16 v[10:11], v163 offset:144
    ds_read_b64_tr_b16 v[12:13], v163 offset:32
    ds_read_b64_tr_b16 v[14:15], v163 offset:176
    ds_read_b64_tr_b16 v[16:17], v163 offset:64
    ds_read_b64_tr_b16 v[18:19], v163 offset:208
    ds_read_b64_tr_b16 v[20:21], v163 offset:96
    ds_read_b64_tr_b16 v[22:23], v163 offset:240
    ds_read_b64_tr_b16 v[24:25], v163 offset:128
    ds_read_b64_tr_b16 v[26:27], v163 offset:272
    ds_read_b64_tr_b16 v[28:29], v163 offset:5184
    ds_read_b64_tr_b16 v[30:31], v163 offset:5328
    ds_read_b64_tr_b16 v[32:33], v163 offset:5216
    ds_read_b64_tr_b16 v[34:35], v163 offset:5360
    ds_read_b64_tr_b16 v[36:37], v163 offset:5248
    ds_read_b64_tr_b16 v[38:39], v163 offset:5392
    ds_read_b64_tr_b16 v[40:41], v163 offset:5280
    ds_read_b64_tr_b16 v[42:43], v163 offset:5424
    ds_read_b64_tr_b16 v[44:45], v163 offset:5312
    ds_read_b64_tr_b16 v[46:47], v163 offset:5456
    ds_read_b64_tr_b16 v[48:49], v163 offset:10368
    ds_read_b64_tr_b16 v[50:51], v163 offset:10512
    ds_read_b64_tr_b16 v[52:53], v163 offset:10400
    ds_read_b64_tr_b16 v[54:55], v163 offset:10544
    ds_read_b64_tr_b16 v[56:57], v163 offset:10432
    ds_read_b64_tr_b16 v[58:59], v163 offset:10576
    ds_read_b64_tr_b16 v[60:61], v163 offset:10464
    ds_read_b64_tr_b16 v[62:63], v163 offset:10608
    ds_read_b64_tr_b16 v[64:65], v163 offset:10496
    ds_read_b64_tr_b16 v[66:67], v163 offset:10640
    v_mov_b32 v140, v82
    v_mov_b32 v141, v98
    s_mov_b32 s29, 0x21800000
    s_mov_b32 s30, 0x5d800000
    v_permlane32_swap_b32 v140, v141
    v_add_f32 v142, |v72|, |v88|
    v_cmp_nle_f32 s[4:5], s29, v140
    v_cmp_nge_f32 s[6:7], s30, v140
    v_rcp_f32 v140, v140
    v_add_f32 v142, v142, |v73|
    v_add_f32 v142, v142, |v89|
    v_add_f32 v142, v142, |v74|
    v_add_f32 v142, v142, |v90|
    v_add_f32 v142, v142, |v75|
    v_add_f32 v142, v142, |v91|
    v_add_f32 v142, v142, |v76|
    v_add_f32 v142, v142, |v92|
    v_add_f32 v142, v142, |v77|
    v_add_f32 v142, v142, |v93|
    v_add_f32 v142, v142, |v78|
    v_add_f32 v142, v142, |v94|
    v_add_f32 v142, v142, |v79|
    v_add_f32 v142, v142, |v95|
    v_add_f32 v142, v142, |v80|
    v_add_f32 v142, v142, |v96|
    v_add_f32 v142, v142, |v81|
    v_add_f32 v142, v142, |v97|
    s_mov_b32 s29, 0x7f000000
    v_mul_f32 v140, v140, v136
    v_cmp_nge_f32 vcc, s29, v142
    v_mov_b32 v141, v140
    s_or_b64 s[4:5], s[4:5], s[6:7]
    s_or_b64 vcc, vcc, s[4:5]
    s_and_b64 vcc, vcc, s[68:69]
    s_cbranch_vccnz L_att_slow
    v_permlane32_swap_b32 v140, v141
    v_mul_f32 v72, v140, v72
    v_mul_f32 v73, v140, v73
    v_mul_f32 v74, v140, v74
    v_mul_f32 v75, v140, v75
    v_mul_f32 v76, v140, v76
    v_mul_f32 v77, v140, v77
    v_mul_f32 v78, v140, v78
    v_mul_f32 v79, v140, v79
    v_mul_f32 v80, v140, v80
    v_mul_f32 v81, v140, v81
    v_cvt_pk_bf16_f32 v144, v72, v73
    v_cvt_pk_bf16_f32 v145, v74, v75
    v_cvt_pk_bf16_f32 v146, v76, v77
    v_cvt_pk_bf16_f32 v147, v78, v79
    v_min_u32 v144, -2, v144
    v_min_u32 v145, -2, v145
    v_min_u32 v146, -2, v146
    v_min_u32 v147, -2, v147
    buffer_store_dwordx4 v[144:147], v2, s[12:15], s33 offen sc1
    v_cvt_pk_bf16_f32 v152, v80, v81
    v_mul_f32 v88, v141, v88
    v_mul_f32 v89, v141, v89
    v_mul_f32 v90, v141, v90
    v_mul_f32 v91, v141, v91
    v_mul_f32 v92, v141, v92
    v_mul_f32 v93, v141, v93
    v_mul_f32 v94, v141, v94
    v_mul_f32 v95, v141, v95
    v_mul_f32 v96, v141, v96
    v_mul_f32 v97, v141, v97
    v_cvt_pk_bf16_f32 v148, v88, v89
    v_cvt_pk_bf16_f32 v149, v90, v91
    v_cvt_pk_bf16_f32 v150, v92, v93
    v_cvt_pk_bf16_f32 v151, v94, v95
    v_min_u32 v148, -2, v148
    v_min_u32 v149, -2, v149
    v_min_u32 v150, -2, v150
    v_min_u32 v151, -2, v151
    buffer_store_dwordx4 v[148:151], v2, s[12:15], s34 offen sc1
    v_cvt_pk_bf16_f32 v153, v96, v97
    s_nop 1
    v_permlane32_swap_b32 v152, v153
    v_min_u32 v152, -2, v152
    buffer_store_dword v152, v3, s[12:15], s35 offen sc1
    v_lshlrev_b32 v4, 4, v1
    s_mul_i32 s29, s38, 5120
    v_add_u32 v5, s29, v4
    ds_read_b64_tr_b16 v[96:97], v163 offset:15552
    ds_read_b64_tr_b16 v[98:99], v163 offset:15696
    ds_read_b64_tr_b16 v[100:101], v163 offset:15584
    ds_read_b64_tr_b16 v[102:103], v163 offset:15728
    ds_read_b64_tr_b16 v[104:105], v163 offset:15616
    ds_read_b64_tr_b16 v[106:107], v163 offset:15760
    ds_read_b64_tr_b16 v[108:109], v163 offset:15648
    ds_read_b64_tr_b16 v[110:111], v163 offset:15792
    ds_read_b64_tr_b16 v[112:113], v163 offset:15680
    ds_read_b64_tr_b16 v[114:115], v163 offset:15824
    ds_read_b64_tr_b16 v[116:117], v163 offset:20736
    ds_read_b64_tr_b16 v[118:119], v163 offset:20880
    ds_read_b64_tr_b16 v[120:121], v163 offset:20768
    ds_read_b64_tr_b16 v[122:123], v163 offset:20912
    ds_read_b64_tr_b16 v[124:125], v163 offset:20800
    ds_read_b64_tr_b16 v[126:127], v163 offset:20944
    ds_read_b64_tr_b16 v[128:129], v163 offset:20832
    ds_read_b64_tr_b16 v[130:131], v163 offset:20976
    ds_read_b64_tr_b16 v[132:133], v163 offset:20864
    ds_read_b64_tr_b16 v[134:135], v163 offset:21008
    s_mov_b32 s41, 262144
    s_waitcnt lgkmcnt(15)
    s_barrier
    buffer_load_dwordx4 v[72:75], v4, s[12:15], s65 offen offset:0 sc1
    buffer_load_dwordx4 v[76:79], v4, s[12:15], s65 offen offset:1024 sc1
    s_waitcnt vmcnt(1)
    v_max3_u32 v156, v72, v73, v74
    v_max_u32 v156, v156, v75
    v_cmp_eq_u32 vcc, -1, v156
    s_cbranch_vccnz L_retry_0
L_have_0:
    s_waitcnt lgkmcnt(15)
    buffer_load_dwordx4 v[80:83], v4, s[12:15], s65 offen offset:2048 sc1
    buffer_load_dwordx4 v[84:87], v4, s[12:15], s65 offen offset:3072 sc1
    v_mfma_f32_16x16x32_bf16 v[136:139], v[8:11], v[72:75], 0
    ds_read_b64_tr_b16 v[8:9], v163 offset:25920
    ds_read_b64_tr_b16 v[10:11], v163 offset:26064
    v_mfma_f32_16x16x32_bf16 v[140:143], v[12:15], v[72:75], 0
    ds_read_b64_tr_b16 v[12:13], v163 offset:25952
    ds_read_b64_tr_b16 v[14:15], v163 offset:26096
    v_mfma_f32_16x16x32_bf16 v[144:147], v[16:19], v[72:75], 0
    ds_read_b64_tr_b16 v[16:17], v163 offset:25984
    ds_read_b64_tr_b16 v[18:19], v163 offset:26128
    s_waitcnt vmcnt(2)
    v_max3_u32 v156, v76, v77, v78
    v_mfma_f32_16x16x32_bf16 v[148:151], v[20:23], v[72:75], 0
    ds_read_b64_tr_b16 v[20:21], v163 offset:26016
    ds_read_b64_tr_b16 v[22:23], v163 offset:26160
    v_max_u32 v156, v156, v79
    v_mfma_f32_16x16x32_bf16 v[152:155], v[24:27], v[72:75], 0
    ds_read_b64_tr_b16 v[24:25], v163 offset:26048
    ds_read_b64_tr_b16 v[26:27], v163 offset:26192
    v_cmp_eq_u32 vcc, -1, v156
    s_cbranch_vccnz L_retry_1
L_have_1:
    s_waitcnt lgkmcnt(15)
    buffer_load_dwordx4 v[72:75], v4, s[12:15], s67 offen offset:0 sc1
    v_mfma_f32_16x16x32_bf16 v[136:139], v[28:31], v[76:79], v[136:139]
    ds_read_b64_tr_b16 v[28:29], v163 offset:31104
    ds_read_b64_tr_b16 v[30:31], v163 offset:31248
    v_mfma_f32_16x16x32_bf16 v[140:143], v[32:35], v[76:79], v[140:143]
    ds_read_b64_tr_b16 v[32:33], v163 offset:31136
    ds_read_b64_tr_b16 v[34:35], v163 offset:31280
    v_mfma_f32_16x16x32_bf16 v[144:147], v[36:39], v[76:79], v[144:147]
    ds_read_b64_tr_b16 v[36:37], v163 offset:31168
    ds_read_b64_tr_b16 v[38:39], v163 offset:31312
    s_waitcnt vmcnt(2)
    v_max3_u32 v156, v80, v81, v82
    v_mfma_f32_16x16x32_bf16 v[148:151], v[40:43], v[76:79], v[148:151]
    ds_read_b64_tr_b16 v[40:41], v163 offset:31200
    ds_read_b64_tr_b16 v[42:43], v163 offset:31344
    v_max_u32 v156, v156, v83
    v_mfma_f32_16x16x32_bf16 v[152:155], v[44:47], v[76:79], v[152:155]
    buffer_load_dwordx4 v[76:79], v4, s[12:15], s67 offen offset:1024 sc1
    ds_read_b64_tr_b16 v[44:45], v163 offset:31232
    ds_read_b64_tr_b16 v[46:47], v163 offset:31376
    v_cmp_eq_u32 vcc, -1, v156
    s_barrier
    s_cbranch_vccnz L_retry_2
L_have_2:
    s_waitcnt lgkmcnt(15)
    v_mfma_f32_16x16x32_bf16 v[136:139], v[48:51], v[80:83], v[136:139]
    ds_read_b64_tr_b16 v[48:49], v163 offset:36288
    ds_read_b64_tr_b16 v[50:51], v163 offset:36432
    v_mfma_f32_16x16x32_bf16 v[140:143], v[52:55], v[80:83], v[140:143]
    ds_read_b64_tr_b16 v[52:53], v163 offset:36320
    ds_read_b64_tr_b16 v[54:55], v163 offset:36464
    v_mfma_f32_16x16x32_bf16 v[144:147], v[56:59], v[80:83], v[144:147]
    ds_read_b64_tr_b16 v[56:57], v163 offset:36352
    ds_read_b64_tr_b16 v[58:59], v163 offset:36496
    s_waitcnt vmcnt(2)
    v_max3_u32 v156, v84, v85, v86
    v_mfma_f32_16x16x32_bf16 v[148:151], v[60:63], v[80:83], v[148:151]
    ds_read_b64_tr_b16 v[60:61], v163 offset:36384
    ds_read_b64_tr_b16 v[62:63], v163 offset:36528
    v_max_u32 v156, v156, v87
    v_mfma_f32_16x16x32_bf16 v[152:155], v[64:67], v[80:83], v[152:155]
    buffer_load_dwordx4 v[80:83], v4, s[12:15], s67 offen offset:2048 sc1
    ds_read_b64_tr_b16 v[64:65], v163 offset:36416
    ds_read_b64_tr_b16 v[66:67], v163 offset:36560
    v_cmp_eq_u32 vcc, -1, v156
    s_cbranch_vccnz L_retry_3
L_have_3:
    s_waitcnt lgkmcnt(15)
    v_mfma_f32_16x16x32_bf16 v[136:139], v[96:99], v[84:87], v[136:139]
    ds_read_b64_tr_b16 v[96:97], v164 offset:0
    ds_read_b64_tr_b16 v[98:99], v164 offset:144
    v_mfma_f32_16x16x32_bf16 v[140:143], v[100:103], v[84:87], v[140:143]
    ds_read_b64_tr_b16 v[100:101], v164 offset:32
    ds_read_b64_tr_b16 v[102:103], v164 offset:176
    v_mfma_f32_16x16x32_bf16 v[144:147], v[104:107], v[84:87], v[144:147]
    ds_read_b64_tr_b16 v[104:105], v164 offset:64
    ds_read_b64_tr_b16 v[106:107], v164 offset:208
    s_waitcnt vmcnt(2)
    v_max3_u32 v156, v72, v73, v74
    v_mfma_f32_16x16x32_bf16 v[148:151], v[108:111], v[84:87], v[148:151]
    ds_read_b64_tr_b16 v[108:109], v164 offset:96
    ds_read_b64_tr_b16 v[110:111], v164 offset:240
    v_max_u32 v156, v156, v75
    v_mfma_f32_16x16x32_bf16 v[152:155], v[112:115], v[84:87], v[152:155]
    buffer_load_dwordx4 v[84:87], v4, s[12:15], s67 offen offset:3072 sc1
    ds_read_b64_tr_b16 v[112:113], v164 offset:128
    ds_read_b64_tr_b16 v[114:115], v164 offset:272
    v_cmp_eq_u32 vcc, -1, v156
    s_cbranch_vccnz L_retry_4
L_have_4:
    s_waitcnt lgkmcnt(15)
    v_mfma_f32_16x16x32_bf16 v[136:139], v[116:119], v[72:75], v[136:139]
    ds_read_b64_tr_b16 v[116:117], v164 offset:5184
    ds_read_b64_tr_b16 v[118:119], v164 offset:5328
    v_mfma_f32_16x16x32_bf16 v[140:143], v[120:123], v[72:75], v[140:143]
    ds_read_b64_tr_b16 v[120:121], v164 offset:5216
    ds_read_b64_tr_b16 v[122:123], v164 offset:5360
    v_mfma_f32_16x16x32_bf16 v[144:147], v[124:127], v[72:75], v[144:147]
    ds_read_b64_tr_b16 v[124:125], v164 offset:5248
    ds_read_b64_tr_b16 v[126:127], v164 offset:5392
    s_waitcnt vmcnt(2)
    v_max3_u32 v156, v76, v77, v78
    v_mfma_f32_16x16x32_bf16 v[148:151], v[128:131], v[72:75], v[148:151]
    ds_read_b64_tr_b16 v[128:129], v164 offset:5280
    ds_read_b64_tr_b16 v[130:131], v164 offset:5424
    v_max_u32 v156, v156, v79
    v_mfma_f32_16x16x32_bf16 v[152:155], v[132:135], v[72:75], v[152:155]
    buffer_load_dwordx4 v[72:75], v4, s[12:15], s70 offen offset:0 sc1
    ds_read_b64_tr_b16 v[132:133], v164 offset:5312
    ds_read_b64_tr_b16 v[134:135], v164 offset:5456
    v_cmp_eq_u32 vcc, -1, v156
    s_cbranch_vccnz L_retry_5
L_have_5:
    s_waitcnt lgkmcnt(15)
    v_mfma_f32_16x16x32_bf16 v[136:139], v[8:11], v[76:79], v[136:139]
    ds_read_b64_tr_b16 v[8:9], v164 offset:10368
    ds_read_b64_tr_b16 v[10:11], v164 offset:10512
    v_mfma_f32_16x16x32_bf16 v[140:143], v[12:15], v[76:79], v[140:143]
    ds_read_b64_tr_b16 v[12:13], v164 offset:10400
    ds_read_b64_tr_b16 v[14:15], v164 offset:10544
    v_mfma_f32_16x16x32_bf16 v[144:147], v[16:19], v[76:79], v[144:147]
    ds_read_b64_tr_b16 v[16:17], v164 offset:10432
    ds_read_b64_tr_b16 v[18:19], v164 offset:10576
    s_waitcnt vmcnt(2)
    v_max3_u32 v156, v80, v81, v82
    v_mfma_f32_16x16x32_bf16 v[148:151], v[20:23], v[76:79], v[148:151]
    ds_read_b64_tr_b16 v[20:21], v164 offset:10464
    ds_read_b64_tr_b16 v[22:23], v164 offset:10608
    v_max_u32 v156, v156, v83
    v_mfma_f32_16x16x32_bf16 v[152:155], v[24:27], v[76:79], v[152:155]
    buffer_load_dwordx4 v[76:79], v4, s[12:15], s70 offen offset:1024 sc1
    ds_read_b64_tr_b16 v[24:25], v164 offset:10496
    ds_read_b64_tr_b16 v[26:27], v164 offset:10640
    v_cmp_eq_u32 vcc, -1, v156
    s_cbranch_vccnz L_retry_6
L_have_6:
    s_waitcnt lgkmcnt(15)
    v_mfma_f32_16x16x32_bf16 v[136:139], v[28:31], v[80:83], v[136:139]
    ds_read_b64_tr_b16 v[28:29], v164 offset:15552
    ds_read_b64_tr_b16 v[30:31], v164 offset:15696
    v_mfma_f32_16x16x32_bf16 v[140:143], v[32:35], v[80:83], v[140:143]
    ds_read_b64_tr_b16 v[32:33], v164 offset:15584
    ds_read_b64_tr_b16 v[34:35], v164 offset:15728
    v_mfma_f32_16x16x32_bf16 v[144:147], v[36:39], v[80:83], v[144:147]
    ds_read_b64_tr_b16 v[36:37], v164 offset:15616
    ds_read_b64_tr_b16 v[38:39], v164 offset:15760
    s_waitcnt vmcnt(2)
    v_max3_u32 v156, v84, v85, v86
    v_mfma_f32_16x16x32_bf16 v[148:151], v[40:43], v[80:83], v[148:151]
    ds_read_b64_tr_b16 v[40:41], v164 offset:15648
    ds_read_b64_tr_b16 v[42:43], v164 offset:15792
    v_max_u32 v156, v156, v87
    v_mfma_f32_16x16x32_bf16 v[152:155], v[44:47], v[80:83], v[152:155]
    buffer_load_dwordx4 v[80:83], v4, s[12:15], s70 offen offset:2048 sc1
    ds_read_b64_tr_b16 v[44:45], v164 offset:15680
    ds_read_b64_tr_b16 v[46:47], v164 offset:15824
    v_cmp_eq_u32 vcc, -1, v156
    s_cbranch_vccnz L_retry_7
L_have_7:
    s_waitcnt lgkmcnt(15)
    v_mfma_f32_16x16x32_bf16 v[136:139], v[48:51], v[84:87], v[136:139]
    ds_read_b64_tr_b16 v[48:49], v164 offset:20736
    ds_read_b64_tr_b16 v[50:51], v164 offset:20880
    v_mfma_f32_16x16x32_bf16 v[140:143], v[52:55], v[84:87], v[140:143]
    ds_read_b64_tr_b16 v[52:53], v164 offset:20768
    ds_read_b64_tr_b16 v[54:55], v164 offset:20912
    v_mfma_f32_16x16x32_bf16 v[144:147], v[56:59], v[84:87], v[144:147]
    ds_read_b64_tr_b16 v[56:57], v164 offset:20800
    ds_read_b64_tr_b16 v[58:59], v164 offset:20944
    s_waitcnt vmcnt(2)
    v_max3_u32 v156, v72, v73, v74
    v_mfma_f32_16x16x32_bf16 v[148:151], v[60:63], v[84:87], v[148:151]
    ds_read_b64_tr_b16 v[60:61], v164 offset:20832
    ds_read_b64_tr_b16 v[62:63], v164 offset:20976
    v_max_u32 v156, v156, v75
    v_mfma_f32_16x16x32_bf16 v[152:155], v[64:67], v[84:87], v[152:155]
    buffer_load_dwordx4 v[84:87], v4, s[12:15], s70 offen offset:3072 sc1
    ds_read_b64_tr_b16 v[64:65], v164 offset:20864
    ds_read_b64_tr_b16 v[66:67], v164 offset:21008
    v_cmp_eq_u32 vcc, -1, v156
    s_cbranch_vccnz L_retry_8
L_have_8:
    s_waitcnt lgkmcnt(15)
    v_mfma_f32_16x16x32_bf16 v[136:139], v[96:99], v[72:75], v[136:139]
    ds_read_b64_tr_b16 v[96:97], v164 offset:25920
    ds_read_b64_tr_b16 v[98:99], v164 offset:26064
    v_mfma_f32_16x16x32_bf16 v[140:143], v[100:103], v[72:75], v[140:143]
    ds_read_b64_tr_b16 v[100:101], v164 offset:25952
    ds_read_b64_tr_b16 v[102:103], v164 offset:26096
    v_mfma_f32_16x16x32_bf16 v[144:147], v[104:107], v[72:75], v[144:147]
    ds_read_b64_tr_b16 v[104:105], v164 offset:25984
    ds_read_b64_tr_b16 v[106:107], v164 offset:26128
    s_waitcnt vmcnt(2)
    v_max3_u32 v156, v76, v77, v78
    v_mfma_f32_16x16x32_bf16 v[148:151], v[108:111], v[72:75], v[148:151]
    ds_read_b64_tr_b16 v[108:109], v164 offset:26016
    ds_read_b64_tr_b16 v[110:111], v164 offset:26160
    v_max_u32 v156, v156, v79
    v_mfma_f32_16x16x32_bf16 v[152:155], v[112:115], v[72:75], v[152:155]
    buffer_load_dwordx4 v[72:75], v4, s[12:15], s71 offen offset:0 sc1
    ds_read_b64_tr_b16 v[112:113], v164 offset:26048
    ds_read_b64_tr_b16 v[114:115], v164 offset:26192
    v_cmp_eq_u32 vcc, -1, v156
    s_cbranch_vccnz L_retry_9
L_have_9:
    s_waitcnt lgkmcnt(15)
    v_mfma_f32_16x16x32_bf16 v[136:139], v[116:119], v[76:79], v[136:139]
    ds_read_b64_tr_b16 v[116:117], v164 offset:31104
    ds_read_b64_tr_b16 v[118:119], v164 offset:31248
    v_mfma_f32_16x16x32_bf16 v[140:143], v[120:123], v[76:79], v[140:143]
    ds_read_b64_tr_b16 v[120:121], v164 offset:31136
    ds_read_b64_tr_b16 v[122:123], v164 offset:31280
    v_mfma_f32_16x16x32_bf16 v[144:147], v[124:127], v[76:79], v[144:147]
    ds_read_b64_tr_b16 v[124:125], v164 offset:31168
    ds_read_b64_tr_b16 v[126:127], v164 offset:31312
    s_waitcnt vmcnt(2)
    v_max3_u32 v156, v80, v81, v82
    v_mfma_f32_16x16x32_bf16 v[148:151], v[128:131], v[76:79], v[148:151]
    ds_read_b64_tr_b16 v[128:129], v164 offset:31200
    ds_read_b64_tr_b16 v[130:131], v164 offset:31344
    v_max_u32 v156, v156, v83
    v_mfma_f32_16x16x32_bf16 v[152:155], v[132:135], v[76:79], v[152:155]
    buffer_load_dwordx4 v[76:79], v4, s[12:15], s71 offen offset:1024 sc1
    ds_read_b64_tr_b16 v[132:133], v164 offset:31232
    ds_read_b64_tr_b16 v[134:135], v164 offset:31376
    v_cmp_eq_u32 vcc, -1, v156
    s_cbranch_vccnz L_retry_10
L_have_10:
    s_waitcnt lgkmcnt(15)
    v_mfma_f32_16x16x32_bf16 v[136:139], v[8:11], v[80:83], v[136:139]
    ds_read_b64_tr_b16 v[8:9], v165 offset:0
    ds_read_b64_tr_b16 v[10:11], v165 offset:144
    v_mfma_f32_16x16x32_bf16 v[140:143], v[12:15], v[80:83], v[140:143]
    ds_read_b64_tr_b16 v[12:13], v165 offset:32
    ds_read_b64_tr_b16 v[14:15], v165 offset:176
    v_mfma_f32_16x16x32_bf16 v[144:147], v[16:19], v[80:83], v[144:147]
    ds_read_b64_tr_b16 v[16:17], v165 offset:64
    ds_read_b64_tr_b16 v[18:19], v165 offset:208
    s_waitcnt vmcnt(2)
    v_max3_u32 v156, v84, v85, v86
    v_mfma_f32_16x16x32_bf16 v[148:151], v[20:23], v[80:83], v[148:151]
    ds_read_b64_tr_b16 v[20:21], v165 offset:96
    ds_read_b64_tr_b16 v[22:23], v165 offset:240
    v_max_u32 v156, v156, v87
    v_mfma_f32_16x16x32_bf16 v[152:155], v[24:27], v[80:83], v[152:155]
    buffer_load_dwordx4 v[80:83], v4, s[12:15], s71 offen offset:2048 sc1
    ds_read_b64_tr_b16 v[24:25], v165 offset:128
    ds_read_b64_tr_b16 v[26:27], v165 offset:272
    v_cmp_eq_u32 vcc, -1, v156
    s_cbranch_vccnz L_retry_11
L_have_11:
    s_waitcnt lgkmcnt(15)
    v_mfma_f32_16x16x32_bf16 v[136:139], v[28:31], v[84:87], v[136:139]
    ds_read_b64_tr_b16 v[28:29], v166 offset:0
    ds_read_b64_tr_b16 v[30:31], v166 offset:20736
    v_mfma_f32_16x16x32_bf16 v[140:143], v[32:35], v[84:87], v[140:143]
    ds_read_b64_tr_b16 v[32:33], v166 offset:32
    ds_read_b64_tr_b16 v[34:35], v166 offset:20768
    v_mfma_f32_16x16x32_bf16 v[144:147], v[36:39], v[84:87], v[144:147]
    ds_read_b64_tr_b16 v[36:37], v166 offset:64
    ds_read_b64_tr_b16 v[38:39], v166 offset:20800
    s_waitcnt vmcnt(2)
    v_max3_u32 v156, v72, v73, v74
    v_mfma_f32_16x16x32_bf16 v[148:151], v[40:43], v[84:87], v[148:151]
    ds_read_b64_tr_b16 v[40:41], v166 offset:96
    ds_read_b64_tr_b16 v[42:43], v166 offset:20832
    v_max_u32 v156, v156, v75
    v_mfma_f32_16x16x32_bf16 v[152:155], v[44:47], v[84:87], v[152:155]
    buffer_load_dwordx4 v[84:87], v4, s[12:15], s71 offen offset:3072 sc1
    ds_read_b64_tr_b16 v[44:45], v166 offset:128
    ds_read_b64_tr_b16 v[46:47], v166 offset:20864
    v_cmp_eq_u32 vcc, -1, v156
    s_cbranch_vccnz L_retry_12
L_have_12:
    s_waitcnt lgkmcnt(15)
    v_mfma_f32_16x16x32_bf16 v[136:139], v[48:51], v[72:75], v[136:139]
    ds_read_b64_tr_b16 v[48:49], v166 offset:41472
    ds_read_b64_tr_b16 v[50:51], v166 offset:62208
    v_mfma_f32_16x16x32_bf16 v[140:143], v[52:55], v[72:75], v[140:143]
    ds_read_b64_tr_b16 v[52:53], v166 offset:41504
    ds_read_b64_tr_b16 v[54:55], v166 offset:62240
    v_mfma_f32_16x16x32_bf16 v[144:147], v[56:59], v[72:75], v[144:147]
    ds_read_b64_tr_b16 v[56:57], v166 offset:41536
    ds_read_b64_tr_b16 v[58:59], v166 offset:62272
    s_waitcnt vmcnt(2)
    v_max3_u32 v156, v76, v77, v78
    v_mfma_f32_16x16x32_bf16 v[148:151], v[60:63], v[72:75], v[148:151]
    ds_read_b64_tr_b16 v[60:61], v166 offset:41568
    ds_read_b64_tr_b16 v[62:63], v166 offset:62304
    v_max_u32 v156, v156, v79
    v_mfma_f32_16x16x32_bf16 v[152:155], v[64:67], v[72:75], v[152:155]
    buffer_load_dwordx4 v[72:75], v4, s[12:15], s3 offen offset:0 sc1
    ds_read_b64_tr_b16 v[64:65], v166 offset:41600
    ds_read_b64_tr_b16 v[66:67], v166 offset:62336
    v_cmp_eq_u32 vcc, -1, v156
    s_cbranch_vccnz L_retry_13
L_have_13:
    s_waitcnt lgkmcnt(15)
    v_mfma_f32_16x16x32_bf16 v[136:139], v[96:99], v[76:79], v[136:139]
    v_mfma_f32_16x16x32_bf16 v[140:143], v[100:103], v[76:79], v[140:143]
    v_mfma_f32_16x16x32_bf16 v[144:147], v[104:107], v[76:79], v[144:147]
    s_waitcnt vmcnt(2)
    v_max3_u32 v156, v80, v81, v82
    v_mfma_f32_16x16x32_bf16 v[148:151], v[108:111], v[76:79], v[148:151]
    v_max_u32 v156, v156, v83
    v_mfma_f32_16x16x32_bf16 v[152:155], v[112:115], v[76:79], v[152:155]
    buffer_load_dwordx4 v[76:79], v4, s[12:15], s3 offen offset:1024 sc1
    v_cmp_eq_u32 vcc, -1, v156
    s_cbranch_vccnz L_retry_14
L_have_14:
    s_waitcnt lgkmcnt(15)
    v_mfma_f32_16x16x32_bf16 v[136:139], v[116:119], v[80:83], v[136:139]
    v_mfma_f32_16x16x32_bf16 v[140:143], v[120:123], v[80:83], v[140:143]
    v_mfma_f32_16x16x32_bf16 v[144:147], v[124:127], v[80:83], v[144:147]
    s_waitcnt vmcnt(2)
    v_max3_u32 v156, v84, v85, v86
    v_mfma_f32_16x16x32_bf16 v[148:151], v[128:131], v[80:83], v[148:151]
    v_max_u32 v156, v156, v87
    v_mfma_f32_16x16x32_bf16 v[152:155], v[132:135], v[80:83], v[152:155]
    v_cmp_eq_u32 vcc, -1, v156
    s_cbranch_vccnz L_retry_15
L_have_15:
    s_waitcnt lgkmcnt(15)
    v_mfma_f32_16x16x32_bf16 v[136:139], v[8:11], v[84:87], v[136:139]
    v_mfma_f32_16x16x32_bf16 v[140:143], v[12:15], v[84:87], v[140:143]
    v_mfma_f32_16x16x32_bf16 v[144:147], v[16:19], v[84:87], v[144:147]
    s_waitcnt vmcnt(1)
    v_max3_u32 v156, v72, v73, v74
    v_mfma_f32_16x16x32_bf16 v[148:151], v[20:23], v[84:87], v[148:151]
    v_max_u32 v156, v156, v75
    v_mfma_f32_16x16x32_bf16 v[152:155], v[24:27], v[84:87], v[152:155]
    v_cmp_eq_u32 vcc, -1, v156
    s_cbranch_vccnz L_retry_16
L_have_16:
    s_waitcnt lgkmcnt(10)
    v_mfma_f32_16x16x32_bf16 v[136:139], v[28:31], v[72:75], v[136:139]
    v_mfma_f32_16x16x32_bf16 v[140:143], v[32:35], v[72:75], v[140:143]
    v_mfma_f32_16x16x32_bf16 v[144:147], v[36:39], v[72:75], v[144:147]
    s_waitcnt vmcnt(0)
    v_max3_u32 v156, v76, v77, v78
    v_mfma_f32_16x16x32_bf16 v[148:151], v[40:43], v[72:75], v[148:151]
    v_max_u32 v156, v156, v79
    v_mfma_f32_16x16x32_bf16 v[152:155], v[44:47], v[72:75], v[152:155]
    v_cmp_eq_u32 vcc, -1, v156
    s_cbranch_vccnz L_retry_17
L_have_17:
    s_waitcnt lgkmcnt(0)
    s_barrier
    v_mfma_f32_16x16x32_bf16 v[136:139], v[48:51], v[76:79], v[136:139]
    v_mfma_f32_16x16x32_bf16 v[140:143], v[52:55], v[76:79], v[140:143]
    v_mfma_f32_16x16x32_bf16 v[144:147], v[56:59], v[76:79], v[144:147]
    v_mfma_f32_16x16x32_bf16 v[148:151], v[60:63], v[76:79], v[148:151]
    v_mfma_f32_16x16x32_bf16 v[152:155], v[64:67], v[76:79], v[152:155]
    s_cmp_eq_u32 s64, 0
    s_cbranch_scc0 L_p3_b
    s_nop 5
    ds_write_b128 v5, v[144:147] offset:2048
    ds_write_b128 v5, v[148:151] offset:3072
    s_waitcnt lgkmcnt(0)
    s_barrier
    ds_read_b128 v[72:75], v5 offset:0
    ds_read_b128 v[76:79], v5 offset:1024
    ds_read_b128 v[80:83], v5 offset:4096
    s_waitcnt lgkmcnt(2)
    v_add_f32 v136, v136, v72
    v_add_f32 v137, v137, v73
    v_add_f32 v138, v138, v74
    v_add_f32 v139, v139, v75
    s_waitcnt lgkmcnt(1)
    v_add_f32 v140, v140, v76
    v_add_f32 v141, v141, v77
    v_add_f32 v142, v142, v78
    v_add_f32 v143, v143, v79
    s_waitcnt lgkmcnt(0)
    v_add_f32 v152, v152, v80
    v_add_f32 v153, v153, v81
    v_add_f32 v154, v154, v82
    v_add_f32 v155, v155, v83
    v_cvt_pk_bf16_f32 v84, v136, v137
    v_cvt_pk_bf16_f32 v85, v138, v139
    v_cvt_pk_bf16_f32 v86, v140, v141
    v_cvt_pk_bf16_f32 v87, v142, v143
    s_nop 1
    v_permlane16_swap_b32 v84, v86
    v_permlane16_swap_b32 v85, v87
    buffer_store_dwordx4 v[84:87], v157, s[20:23], 0 offen offset:0
    v_cvt_pk_bf16_f32 v88, v152, v153
    v_cvt_pk_bf16_f32 v89, v154, v155
    s_mov_b32 exec_hi, 0
    buffer_store_dwordx2 v[88:89], v158, s[20:23], 0 offen offset:128
    s_endpgm
L_p3_b:
    s_nop 5
    ds_write_b128 v5, v[136:139] offset:0
    ds_write_b128 v5, v[140:143] offset:1024
    ds_write_b128 v5, v[152:155] offset:4096
    s_waitcnt lgkmcnt(0)
    s_barrier
    ds_read_b128 v[72:75], v5 offset:2048
    ds_read_b128 v[76:79], v5 offset:3072
    s_waitcnt lgkmcnt(1)
    v_add_f32 v144, v144, v72
    v_add_f32 v145, v145, v73
    v_add_f32 v146, v146, v74
    v_add_f32 v147, v147, v75
    s_waitcnt lgkmcnt(0)
    v_add_f32 v148, v148, v76
    v_add_f32 v149, v149, v77
    v_add_f32 v150, v150, v78
    v_add_f32 v151, v151, v79
    v_cvt_pk_bf16_f32 v84, v144, v145
    v_cvt_pk_bf16_f32 v85, v146, v147
    v_cvt_pk_bf16_f32 v86, v148, v149
    v_cvt_pk_bf16_f32 v87, v150, v151
    s_nop 1
    v_permlane16_swap_b32 v84, v86
    v_permlane16_swap_b32 v85, v87
    buffer_store_dwordx4 v[84:87], v157, s[20:23], 0 offen offset:64
    s_endpgm
L_retry_0:
    s_waitcnt vmcnt(0)
    s_sleep 1
    buffer_load_dwordx4 v[72:75], v4, s[12:15], s65 offen offset:0 sc1
    buffer_load_dwordx4 v[76:79], v4, s[12:15], s65 offen offset:1024 sc1
    s_max_u32 s41, s41, 1
    s_sub_u32 s41, s41, 1
    s_waitcnt vmcnt(1)
    v_max3_u32 v156, v72, v73, v74
    v_max_u32 v156, v156, v75
    v_cmp_eq_u32 vcc, -1, v156
    s_cmp_eq_u32 s41, 0
    s_cbranch_scc1 L_have_0
    s_cbranch_vccnz L_retry_0
    s_branch L_have_0
L_retry_1:
    s_waitcnt vmcnt(0)
    s_sleep 1
    buffer_load_dwordx4 v[76:79], v4, s[12:15], s65 offen offset:1024 sc1
    buffer_load_dwordx4 v[80:83], v4, s[12:15], s65 offen offset:2048 sc1
    buffer_load_dwordx4 v[84:87], v4, s[12:15], s65 offen offset:3072 sc1
    s_max_u32 s41, s41, 1
    s_sub_u32 s41, s41, 1
    s_waitcnt vmcnt(2)
    v_max3_u32 v156, v76, v77, v78
    v_max_u32 v156, v156, v79
    v_cmp_eq_u32 vcc, -1, v156
    s_cmp_eq_u32 s41, 0
    s_cbranch_scc1 L_have_1
    s_cbranch_vccnz L_retry_1
    s_branch L_have_1
L_retry_2:
    s_waitcnt vmcnt(0)
    s_sleep 1
    buffer_load_dwordx4 v[80:83], v4, s[12:15], s65 offen offset:2048 sc1
    buffer_load_dwordx4 v[84:87], v4, s[12:15], s65 offen offset:3072 sc1
    buffer_load_dwordx4 v[72:75], v4, s[12:15], s67 offen offset:0 sc1
    buffer_load_dwordx4 v[76:79], v4, s[12:15], s67 offen offset:1024 sc1
    s_max_u32 s41, s41, 1
    s_sub_u32 s41, s41, 1
    s_waitcnt vmcnt(3)
    v_max3_u32 v156, v80, v81, v82
    v_max_u32 v156, v156, v83
    v_cmp_eq_u32 vcc, -1, v156
    s_cmp_eq_u32 s41, 0
    s_cbranch_scc1 L_have_2
    s_cbranch_vccnz L_retry_2
    s_branch L_have_2
L_retry_3:
    s_waitcnt vmcnt(0)
    s_sleep 1
    buffer_load_dwordx4 v[84:87], v4, s[12:15], s65 offen offset:3072 sc1
    buffer_load_dwordx4 v[72:75], v4, s[12:15], s67 offen offset:0 sc1
    buffer_load_dwordx4 v[76:79], v4, s[12:15], s67 offen offset:1024 sc1
    buffer_load_dwordx4 v[80:83], v4, s[12:15], s67 offen offset:2048 sc1
    s_max_u32 s41, s41, 1
    s_sub_u32 s41, s41, 1
    s_waitcnt vmcnt(3)
    v_max3_u32 v156, v84, v85, v86
    v_max_u32 v156, v156, v87
    v_cmp_eq_u32 vcc, -1, v156
    s_cmp_eq_u32 s41, 0
    s_cbranch_scc1 L_have_3
    s_cbranch_vccnz L_retry_3
    s_branch L_have_3
L_retry_4:
    s_waitcnt vmcnt(0)
    s_sleep 1
    buffer_load_dwordx4 v[72:75], v4, s[12:15], s67 offen offset:0 sc1
    buffer_load_dwordx4 v[76:79], v4, s[12:15], s67 offen offset:1024 sc1
    buffer_load_dwordx4 v[80:83], v4, s[12:15], s67 offen offset:2048 sc1
    buffer_load_dwordx4 v[84:87], v4, s[12:15], s67 offen offset:3072 sc1
    s_max_u32 s41, s41, 1
    s_sub_u32 s41, s41, 1
    s_waitcnt vmcnt(3)
    v_max3_u32 v156, v72, v73, v74
    v_max_u32 v156, v156, v75
    v_cmp_eq_u32 vcc, -1, v156
    s_cmp_eq_u32 s41, 0
    s_cbranch_scc1 L_have_4
    s_cbranch_vccnz L_retry_4
    s_branch L_have_4
L_retry_5:
    s_waitcnt vmcnt(0)
    s_sleep 1
    buffer_load_dwordx4 v[76:79], v4, s[12:15], s67 offen offset:1024 sc1
    buffer_load_dwordx4 v[80:83], v4, s[12:15], s67 offen offset:2048 sc1
    buffer_load_dwordx4 v[84:87], v4, s[12:15], s67 offen offset:3072 sc1
    buffer_load_dwordx4 v[72:75], v4, s[12:15], s70 offen offset:0 sc1
    s_max_u32 s41, s41, 1
    s_sub_u32 s41, s41, 1
    s_waitcnt vmcnt(3)
    v_max3_u32 v156, v76, v77, v78
    v_max_u32 v156, v156, v79
    v_cmp_eq_u32 vcc, -1, v156
    s_cmp_eq_u32 s41, 0
    s_cbranch_scc1 L_have_5
    s_cbranch_vccnz L_retry_5
    s_branch L_have_5
L_retry_6:
    s_waitcnt vmcnt(0)
    s_sleep 1
    buffer_load_dwordx4 v[80:83], v4, s[12:15], s67 offen offset:2048 sc1
    buffer_load_dwordx4 v[84:87], v4, s[12:15], s67 offen offset:3072 sc1
    buffer_load_dwordx4 v[72:75], v4, s[12:15], s70 offen offset:0 sc1
    buffer_load_dwordx4 v[76:79], v4, s[12:15], s70 offen offset:1024 sc1
    s_max_u32 s41, s41, 1
    s_sub_u32 s41, s41, 1
    s_waitcnt vmcnt(3)
    v_max3_u32 v156, v80, v81, v82
    v_max_u32 v156, v156, v83
    v_cmp_eq_u32 vcc, -1, v156
    s_cmp_eq_u32 s41, 0
    s_cbranch_scc1 L_have_6
    s_cbranch_vccnz L_retry_6
    s_branch L_have_6
L_retry_7:
    s_waitcnt vmcnt(0)
    s_sleep 1
    buffer_load_dwordx4 v[84:87], v4, s[12:15], s67 offen offset:3072 sc1
    buffer_load_dwordx4 v[72:75], v4, s[12:15], s70 offen offset:0 sc1
    buffer_load_dwordx4 v[76:79], v4, s[12:15], s70 offen offset:1024 sc1
    buffer_load_dwordx4 v[80:83], v4, s[12:15], s70 offen offset:2048 sc1
    s_max_u32 s41, s41, 1
    s_sub_u32 s41, s41, 1
    s_waitcnt vmcnt(3)
    v_max3_u32 v156, v84, v85, v86
    v_max_u32 v156, v156, v87
    v_cmp_eq_u32 vcc, -1, v156
    s_cmp_eq_u32 s41, 0
    s_cbranch_scc1 L_have_7
    s_cbranch_vccnz L_retry_7
    s_branch L_have_7
L_retry_8:
    s_waitcnt vmcnt(0)
    s_sleep 1
    buffer_load_dwordx4 v[72:75], v4, s[12:15], s70 offen offset:0 sc1
    buffer_load_dwordx4 v[76:79], v4, s[12:15], s70 offen offset:1024 sc1
    buffer_load_dwordx4 v[80:83], v4, s[12:15], s70 offen offset:2048 sc1
    buffer_load_dwordx4 v[84:87], v4, s[12:15], s70 offen offset:3072 sc1
    s_max_u32 s41, s41, 1
    s_sub_u32 s41, s41, 1
    s_waitcnt vmcnt(3)
    v_max3_u32 v156, v72, v73, v74
    v_max_u32 v156, v156, v75
    v_cmp_eq_u32 vcc, -1, v156
    s_cmp_eq_u32 s41, 0
    s_cbranch_scc1 L_have_8
    s_cbranch_vccnz L_retry_8
    s_branch L_have_8
L_retry_9:
    s_waitcnt vmcnt(0)
    s_sleep 1
    buffer_load_dwordx4 v[76:79], v4, s[12:15], s70 offen offset:1024 sc1
    buffer_load_dwordx4 v[80:83], v4, s[12:15], s70 offen offset:2048 sc1
    buffer_load_dwordx4 v[84:87], v4, s[12:15], s70 offen offset:3072 sc1
    buffer_load_dwordx4 v[72:75], v4, s[12:15], s71 offen offset:0 sc1
    s_max_u32 s41, s41, 1
    s_sub_u32 s41, s41, 1
    s_waitcnt vmcnt(3)
    v_max3_u32 v156, v76, v77, v78
    v_max_u32 v156, v156, v79
    v_cmp_eq_u32 vcc, -1, v156
    s_cmp_eq_u32 s41, 0
    s_cbranch_scc1 L_have_9
    s_cbranch_vccnz L_retry_9
    s_branch L_have_9
L_retry_10:
    s_waitcnt vmcnt(0)
    s_sleep 1
    buffer_load_dwordx4 v[80:83], v4, s[12:15], s70 offen offset:2048 sc1
    buffer_load_dwordx4 v[84:87], v4, s[12:15], s70 offen offset:3072 sc1
    buffer_load_dwordx4 v[72:75], v4, s[12:15], s71 offen offset:0 sc1
    buffer_load_dwordx4 v[76:79], v4, s[12:15], s71 offen offset:1024 sc1
    s_max_u32 s41, s41, 1
    s_sub_u32 s41, s41, 1
    s_waitcnt vmcnt(3)
    v_max3_u32 v156, v80, v81, v82
    v_max_u32 v156, v156, v83
    v_cmp_eq_u32 vcc, -1, v156
    s_cmp_eq_u32 s41, 0
    s_cbranch_scc1 L_have_10
    s_cbranch_vccnz L_retry_10
    s_branch L_have_10
L_retry_11:
    s_waitcnt vmcnt(0)
    s_sleep 1
    buffer_load_dwordx4 v[84:87], v4, s[12:15], s70 offen offset:3072 sc1
    buffer_load_dwordx4 v[72:75], v4, s[12:15], s71 offen offset:0 sc1
    buffer_load_dwordx4 v[76:79], v4, s[12:15], s71 offen offset:1024 sc1
    buffer_load_dwordx4 v[80:83], v4, s[12:15], s71 offen offset:2048 sc1
    s_max_u32 s41, s41, 1
    s_sub_u32 s41, s41, 1
    s_waitcnt vmcnt(3)
    v_max3_u32 v156, v84, v85, v86
    v_max_u32 v156, v156, v87
    v_cmp_eq_u32 vcc, -1, v156
    s_cmp_eq_u32 s41, 0
    s_cbranch_scc1 L_have_11
    s_cbranch_vccnz L_retry_11
    s_branch L_have_11
L_retry_12:
    s_waitcnt vmcnt(0)
    s_sleep 1
    buffer_load_dwordx4 v[72:75], v4, s[12:15], s71 offen offset:0 sc1
    buffer_load_dwordx4 v[76:79], v4, s[12:15], s71 offen offset:1024 sc1
    buffer_load_dwordx4 v[80:83], v4, s[12:15], s71 offen offset:2048 sc1
    buffer_load_dwordx4 v[84:87], v4, s[12:15], s71 offen offset:3072 sc1
    s_max_u32 s41, s41, 1
    s_sub_u32 s41, s41, 1
    s_waitcnt vmcnt(3)
    v_max3_u32 v156, v72, v73, v74
    v_max_u32 v156, v156, v75
    v_cmp_eq_u32 vcc, -1, v156
    s_cmp_eq_u32 s41, 0
    s_cbranch_scc1 L_have_12
    s_cbranch_vccnz L_retry_12
    s_branch L_have_12
L_retry_13:
    s_waitcnt vmcnt(0)
    s_sleep 1
    buffer_load_dwordx4 v[76:79], v4, s[12:15], s71 offen offset:1024 sc1
    buffer_load_dwordx4 v[80:83], v4, s[12:15], s71 offen offset:2048 sc1
    buffer_load_dwordx4 v[84:87], v4, s[12:15], s71 offen offset:3072 sc1
    buffer_load_dwordx4 v[72:75], v4, s[12:15], s3 offen offset:0 sc1
    s_max_u32 s41, s41, 1
    s_sub_u32 s41, s41, 1
    s_waitcnt vmcnt(3)
    v_max3_u32 v156, v76, v77, v78
    v_max_u32 v156, v156, v79
    v_cmp_eq_u32 vcc, -1, v156
    s_cmp_eq_u32 s41, 0
    s_cbranch_scc1 L_have_13
    s_cbranch_vccnz L_retry_13
    s_branch L_have_13
L_retry_14:
    s_waitcnt vmcnt(0)
    s_sleep 1
    buffer_load_dwordx4 v[80:83], v4, s[12:15], s71 offen offset:2048 sc1
    buffer_load_dwordx4 v[84:87], v4, s[12:15], s71 offen offset:3072 sc1
    buffer_load_dwordx4 v[72:75], v4, s[12:15], s3 offen offset:0 sc1
    buffer_load_dwordx4 v[76:79], v4, s[12:15], s3 offen offset:1024 sc1
    s_max_u32 s41, s41, 1
    s_sub_u32 s41, s41, 1
    s_waitcnt vmcnt(3)
    v_max3_u32 v156, v80, v81, v82
    v_max_u32 v156, v156, v83
    v_cmp_eq_u32 vcc, -1, v156
    s_cmp_eq_u32 s41, 0
    s_cbranch_scc1 L_have_14
    s_cbranch_vccnz L_retry_14
    s_branch L_have_14
L_retry_15:
    s_waitcnt vmcnt(0)
    s_sleep 1
    buffer_load_dwordx4 v[84:87], v4, s[12:15], s71 offen offset:3072 sc1
    buffer_load_dwordx4 v[72:75], v4, s[12:15], s3 offen offset:0 sc1
    buffer_load_dwordx4 v[76:79], v4, s[12:15], s3 offen offset:1024 sc1
    s_max_u32 s41, s41, 1
    s_sub_u32 s41, s41, 1
    s_waitcnt vmcnt(2)
    v_max3_u32 v156, v84, v85, v86
    v_max_u32 v156, v156, v87
    v_cmp_eq_u32 vcc, -1, v156
    s_cmp_eq_u32 s41, 0
    s_cbranch_scc1 L_have_15
    s_cbranch_vccnz L_retry_15
    s_branch L_have_15
L_retry_16:
    s_waitcnt vmcnt(0)
    s_sleep 1
    buffer_load_dwordx4 v[72:75], v4, s[12:15], s3 offen offset:0 sc1
    buffer_load_dwordx4 v[76:79], v4, s[12:15], s3 offen offset:1024 sc1
    s_max_u32 s41, s41, 1
    s_sub_u32 s41, s41, 1
    s_waitcnt vmcnt(1)
    v_max3_u32 v156, v72, v73, v74
    v_max_u32 v156, v156, v75
    v_cmp_eq_u32 vcc, -1, v156
    s_cmp_eq_u32 s41, 0
    s_cbranch_scc1 L_have_16
    s_cbranch_vccnz L_retry_16
    s_branch L_have_16
L_retry_17:
    s_waitcnt vmcnt(0)
    s_sleep 1
    buffer_load_dwordx4 v[76:79], v4, s[12:15], s3 offen offset:1024 sc1
    s_max_u32 s41, s41, 1
    s_sub_u32 s41, s41, 1
    s_waitcnt vmcnt(0)
    v_max3_u32 v156, v76, v77, v78
    v_max_u32 v156, v156, v79
    v_cmp_eq_u32 vcc, -1, v156
    s_cmp_eq_u32 s41, 0
    s_cbranch_scc1 L_have_17
    s_cbranch_vccnz L_retry_17
    s_branch L_have_17
L_att_slow:
    s_mov_b64 s[68:69], 0
    v_mov_b32 v113, 0
    v_mov_b32 v154, 0xff800000
    v_mov_b32 v155, 0xff800000
    s_waitcnt vmcnt(0) lgkmcnt(0)
    v_mov_b32 v72, 0
    v_mov_b32 v73, 0
    v_mov_b32 v74, 0
    v_mov_b32 v75, 0
    v_mov_b32 v76, 0
    v_mov_b32 v77, 0
    v_mov_b32 v78, 0
    v_mov_b32 v79, 0
    v_mov_b32 v80, 0
    v_mov_b32 v81, 0
    v_mov_b32 v82, 0
    v_mov_b32 v83, 0
    v_mov_b32 v84, 0
    v_mov_b32 v85, 0
    v_mov_b32 v86, 0
    v_mov_b32 v87, 0
    v_mov_b32 v88, 0
    v_mov_b32 v89, 0
    v_mov_b32 v90, 0
    v_mov_b32 v91, 0
    v_mov_b32 v92, 0
    v_mov_b32 v93, 0
    v_mov_b32 v94, 0
    v_mov_b32 v95, 0
    v_mov_b32 v96, 0
    v_mov_b32 v97, 0
    v_mov_b32 v98, 0
    v_mov_b32 v99, 0
    v_mov_b32 v100, 0
    v_mov_b32 v101, 0
    v_mov_b32 v102, 0
    v_mov_b32 v103, 0
    s_mov_b32 s41, 0
L_slow_0:
    s_lshr_b32 s29, s41, 1
    s_bfe_u32 s30, s41, 0x30003
    s_lshl_b32 s30, s30, 2
    s_add_u32 s29, s29, s30
    s_mul_i32 s29, s29, 5120
    s_add_u32 s29, s29, s39
    s_and_b32 s30, s41, 1
    s_lshl_b32 s31, s30, 10
    s_add_u32 s31, s31, s29
    buffer_load_dwordx4 v[116:119], v160, s[12:15], s31 offen sc1
    s_lshl_b32 s31, s30, 3
    s_add_u32 s31, s31, s29
    buffer_load_dwordx2 v[120:121], v161, s[12:15], s31 offen sc1
    s_mul_i32 s31, s30, 1280
    s_add_u32 s31, s31, s29
    buffer_load_dwordx4 v[124:127], v162, s[12:15], s31 offen sc1
    buffer_load_dwordx4 v[128:131], v162, s[12:15], s31 offen offset:640 sc1
    s_waitcnt vmcnt(0)
    v_mfma_f32_32x32x4_2b_bf16 v[8:39], v[120:121], v[112:113], 0
    s_nop 15
    s_nop 3
    v_mfma_f32_32x32x16_bf16 v[8:23], v[116:119], v[104:107], v[8:23]
    v_mfma_f32_32x32x16_bf16 v[24:39], v[116:119], v[108:111], v[24:39]
    s_nop 13
    v_max3_f32 v154, v154, v8, v9
    v_max3_f32 v154, v154, v10, v11
    v_max3_f32 v154, v154, v12, v13
    v_max3_f32 v154, v154, v14, v15
    v_max3_f32 v154, v154, v16, v17
    v_max3_f32 v154, v154, v18, v19
    v_max3_f32 v154, v154, v20, v21
    v_max3_f32 v154, v154, v22, v23
    v_max3_f32 v155, v155, v24, v25
    v_max3_f32 v155, v155, v26, v27
    v_max3_f32 v155, v155, v28, v29
    v_max3_f32 v155, v155, v30, v31
    v_max3_f32 v155, v155, v32, v33
    v_max3_f32 v155, v155, v34, v35
    v_max3_f32 v155, v155, v36, v37
    v_max3_f32 v155, v155, v38, v39
    s_add_u32 s41, s41, 1
    s_cmp_lt_u32 s41, 64
    s_cbranch_scc1 L_slow_0
    v_mov_b32 v156, v154
    s_nop 1
    v_permlane32_swap_b32 v156, v154
    v_max_f32 v154, v154, v156
    v_mov_b32 v156, v155
    s_nop 1
    v_permlane32_swap_b32 v156, v155
    v_max_f32 v155, v155, v156
    s_mov_b32 s41, 0
L_slow_1:
    s_lshr_b32 s29, s41, 1
    s_bfe_u32 s30, s41, 0x30003
    s_lshl_b32 s30, s30, 2
    s_add_u32 s29, s29, s30
    s_mul_i32 s29, s29, 5120
    s_add_u32 s29, s29, s39
    s_and_b32 s30, s41, 1
    s_lshl_b32 s31, s30, 10
    s_add_u32 s31, s31, s29
    buffer_load_dwordx4 v[116:119], v160, s[12:15], s31 offen sc1
    s_lshl_b32 s31, s30, 3
    s_add_u32 s31, s31, s29
    buffer_load_dwordx2 v[120:121], v161, s[12:15], s31 offen sc1
    s_mul_i32 s31, s30, 1280
    s_add_u32 s31, s31, s29
    buffer_load_dwordx4 v[124:127], v162, s[12:15], s31 offen sc1
    buffer_load_dwordx4 v[128:131], v162, s[12:15], s31 offen offset:640 sc1
    s_waitcnt vmcnt(0)
    v_mfma_f32_32x32x4_2b_bf16 v[8:39], v[120:121], v[112:113], 0
    s_nop 15
    s_nop 3
    v_mfma_f32_32x32x16_bf16 v[8:23], v[116:119], v[104:107], v[8:23]
    v_mfma_f32_32x32x16_bf16 v[24:39], v[116:119], v[108:111], v[24:39]
    s_nop 13
    v_sub_f32 v8, v8, v154
    v_sub_f32 v9, v9, v154
    v_sub_f32 v10, v10, v154
    v_sub_f32 v11, v11, v154
    v_sub_f32 v12, v12, v154
    v_sub_f32 v13, v13, v154
    v_sub_f32 v14, v14, v154
    v_sub_f32 v15, v15, v154
    v_sub_f32 v16, v16, v154
    v_sub_f32 v17, v17, v154
    v_sub_f32 v18, v18, v154
    v_sub_f32 v19, v19, v154
    v_sub_f32 v20, v20, v154
    v_sub_f32 v21, v21, v154
    v_sub_f32 v22, v22, v154
    v_sub_f32 v23, v23, v154
    v_sub_f32 v24, v24, v155
    v_sub_f32 v25, v25, v155
    v_sub_f32 v26, v26, v155
    v_sub_f32 v27, v27, v155
    v_sub_f32 v28, v28, v155
    v_sub_f32 v29, v29, v155
    v_sub_f32 v30, v30, v155
    v_sub_f32 v31, v31, v155
    v_sub_f32 v32, v32, v155
    v_sub_f32 v33, v33, v155
    v_sub_f32 v34, v34, v155
    v_sub_f32 v35, v35, v155
    v_sub_f32 v36, v36, v155
    v_sub_f32 v37, v37, v155
    v_sub_f32 v38, v38, v155
    v_sub_f32 v39, v39, v155
    v_exp_f32 v8, v8
    v_exp_f32 v9, v9
    v_exp_f32 v10, v10
    v_exp_f32 v11, v11
    v_exp_f32 v12, v12
    v_exp_f32 v13, v13
    v_exp_f32 v14, v14
    v_exp_f32 v15, v15
    v_exp_f32 v16, v16
    v_exp_f32 v17, v17
    v_exp_f32 v18, v18
    v_exp_f32 v19, v19
    v_exp_f32 v20, v20
    v_exp_f32 v21, v21
    v_exp_f32 v22, v22
    v_exp_f32 v23, v23
    v_exp_f32 v24, v24
    v_exp_f32 v25, v25
    v_exp_f32 v26, v26
    v_exp_f32 v27, v27
    v_exp_f32 v28, v28
    v_exp_f32 v29, v29
    v_exp_f32 v30, v30
    v_exp_f32 v31, v31
    v_exp_f32 v32, v32
    v_exp_f32 v33, v33
    v_exp_f32 v34, v34
    v_exp_f32 v35, v35
    v_exp_f32 v36, v36
    v_exp_f32 v37, v37
    v_exp_f32 v38, v38
    v_exp_f32 v39, v39
    s_nop 1
    v_smfmac_f32_32x32x32_bf16 v[72:87], v[124:127], v[8:15], v132
    v_smfmac_f32_32x32x32_bf16 v[72:87], v[128:131], v[16:23], v132
    v_smfmac_f32_32x32x32_bf16 v[88:103], v[124:127], v[24:31], v132
    v_smfmac_f32_32x32x32_bf16 v[88:103], v[128:131], v[32:39], v132
    s_nop 13
    s_add_u32 s41, s41, 1
    s_cmp_lt_u32 s41, 64
    s_cbranch_scc1 L_slow_1
    s_branch L_att_norm
L_exit:
    s_endpgm
.section .rodata,"a"
.p2align 6
.amdhsa_kernel gated_mix__softmax_full_mha__softmax_full_mha__prompt_kernel
  .amdhsa_next_free_vgpr 168
  .amdhsa_next_free_sgpr 72
  .amdhsa_accum_offset 168
  .amdhsa_group_segment_fixed_size 0
  .amdhsa_kernarg_size 80
  .amdhsa_user_sgpr_count 2
  .amdhsa_user_sgpr_kernarg_segment_ptr 1
  .amdhsa_system_sgpr_workgroup_id_x 1
.end_amdhsa_kernel
```
